```python
import torch

def _softmax(x, axis=-1):
    return torch.softmax(x, dim=axis)
def _gelu(x):
    return torch.nn.functional.gelu(x, approximate="tanh")
def _silu(x):
    return torch.nn.functional.silu(x)
def _sigmoid(x):
    return torch.sigmoid(x)
def _layernorm(x, axis=-1, eps=1e-5):
    m = x.mean(dim=axis, keepdim=True)
    v = x.var(dim=axis, keepdim=True, unbiased=False)
    return (x - m) / torch.sqrt(v + eps)
def _scatter_add(tgt, idx, src, axis=0):
    return tgt.clone().index_add_(axis, idx, src)
def _segment_sum(src, seg, n):
    out = torch.zeros((n,) + src.shape[1:], dtype=src.dtype)
    return out.index_add_(0, seg, src)
def _pad(x, pw):
    flat = tuple(v for pair in reversed(pw) for v in pair)
    return torch.nn.functional.pad(x, flat)

kernel_name = 'gated_mix__linear_kernel_hedgehog__mixer_token_mlp__prompt'

def setup_inputs():

    _w = (lambda a: (lambda t: t.to(torch.bfloat16) if t.is_floating_point() else t)(torch.as_tensor(a)))
    def _A_setup():
        B, S, D, H = 1, 2048, 512, 32
        Dh = D // H
        return {
            "x": _w((lambda *s: torch.randn(*s, dtype=torch.bfloat16) * 0.05)(B, S, D)),
            "wqkv": _w((lambda *s: torch.randn(*s, dtype=torch.bfloat16) * 0.8)(D, 3 * D)),
            "w_phi": _w((lambda *s: torch.randn(*s, dtype=torch.bfloat16) * 0.8)(H, Dh, Dh) * (Dh ** -0.5)),
            "wo": _w((lambda *s: torch.randn(*s, dtype=torch.bfloat16) * 0.05)(D, D)),
        }
    _A_in = _A_setup()

    def _B_setup():
        B, S, D, F = 1, 2048, 512, 1792
        return {
            "x": _w((lambda *s: torch.randn(*s, dtype=torch.bfloat16) * 0.05)(B, S, D)),
            "w1": _w((lambda *s: torch.randn(*s, dtype=torch.bfloat16) * 0.4)(S, F) * (S ** -0.5)),
            "b1": _w((lambda *s: torch.randn(*s, dtype=torch.bfloat16) * 3.2)(F) * 0.02),
            "w2": _w((lambda *s: torch.randn(*s, dtype=torch.bfloat16) * 0.1)(F, S) * (F ** -0.5)),
            "b2": _w((lambda *s: torch.randn(*s, dtype=torch.bfloat16) * 0.4)(S) * 0.02),
        }
    _B_in = _B_setup()

    return {
        "A_x": _A_in["x"],
        "A_wqkv": _A_in["wqkv"],
        "A_w_phi": _A_in["w_phi"],
        "A_wo": _A_in["wo"],
        "B_x": _B_in["x"],
        "B_w1": _B_in["w1"],
        "B_b1": _B_in["b1"],
        "B_w2": _B_in["w2"],
        "B_b2": _B_in["b2"],
        "gate_w": _w((lambda *s: torch.randn(*s, dtype=torch.bfloat16) * 0.05)(512) * 16.0),
    }

def reference(A_x, A_wqkv, A_w_phi, A_wo, B_x, B_w1, B_b1, B_w2, B_b2, gate_w):
    def _A_ref(x, wqkv, w_phi, wo):
        B, S, D = x.shape
        H = 32; Dh = D // H
        qkv = (lambda x, *d: x.permute(*d))((x @ wqkv).reshape(B, S, 3, H, Dh), 2, 0, 3, 1, 4)
        q, k, v = qkv[0], qkv[1], qkv[2]
        pq = torch.einsum("bhsd,hdf->bhsf", q, w_phi)
        pk = torch.einsum("bhsd,hdf->bhsf", k, w_phi)
        phi_q = torch.concatenate([_softmax(pq, axis=-1), _softmax(-pq, axis=-1)], axis=-1)
        phi_k = torch.concatenate([_softmax(pk, axis=-1), _softmax(-pk, axis=-1)], axis=-1)
        kv = torch.einsum("bhsf,bhsd->bhfd", phi_k, v)
        z  = torch.einsum("bhsf->bhf", phi_k)
        num = torch.einsum("bhqf,bhfd->bhqd", phi_q, kv)
        den = torch.einsum("bhqf,bhf->bhq", phi_q, z)[..., None] + 1e-6
        o = num / den
        return (lambda x, *d: x.permute(*d))(o, 0, 2, 1, 3).reshape(B, S, D) @ wo

    def _B_ref(x, w1, b1, w2, b2):
        B, S, D = x.shape
        h = _layernorm(x, axis=-1)
        u = torch.einsum("bsd,sf->bdf", h, w1) + b1
        u = _gelu(u)
        y = torch.einsum("bdf,fs->bds", u, w2) + b2
        return (lambda x, *d: x.permute(*d))(y, 0, 2, 1)

    x = A_x
    g = _sigmoid((x * gate_w).sum(-1, keepdims=True))
    a = _A_ref(x, A_wqkv, A_w_phi, A_wo)
    b = _B_ref(x, B_w1, B_b1, B_w2, B_b2)
    return g * a + (1 - g) * b
```

```asm
; @launch grid=(256,1,1) block=(256,1,1) lds=163840
.amdgcn_target "amdgcn-amd-amdhsa--gfx950"
.text
.globl gated_mix__linear_kernel_hedgehog__mixer_token_mlp__prompt_kernel
.p2align 8
.type gated_mix__linear_kernel_hedgehog__mixer_token_mlp__prompt_kernel,@function
gated_mix__linear_kernel_hedgehog__mixer_token_mlp__prompt_kernel:
    s_cmp_ge_u32 s2, 256
    s_cbranch_scc1 L_end
    s_load_dwordx16 s[36:51], s[0:1], 0
    s_load_dwordx8 s[52:59], s[0:1], 64
    s_load_dwordx2 s[60:61], s[0:1], 96
    s_getpc_b64 s[66:67]
L_pc:
    s_lshl_b32 s3, s2, 5
    s_add_u32 s3, s3, L_table-L_pc
    s_load_dwordx4 s[68:71], s[66:67], s3
    s_add_u32 s3, s3, 16
    s_load_dwordx2 s[72:73], s[66:67], s3
    s_and_b32 s30, s2, 7
    s_lshr_b32 s29, s2, 3
    s_and_b32 s4, s29, 7
    s_lshl_b32 s3, s4, 12
    v_lshl_add_u32 v7, v0, 4, s3
    global_load_dwordx4 v[232:235], v7, s[66:67]
    v_and_b32 v1, 63, v0
    v_lshrrev_b32 v2, 6, v0
    s_lshr_b32 s3, s30, 1
    s_lshl_b32 s3, s3, 3
    s_add_u32 s25, s3, s4
    v_readfirstlane_b32 s24, v2
    v_lshrrev_b32 v2, 3, v1
    v_and_b32 v3, 7, v1
    v_lshrrev_b32 v4, 4, v1
    s_and_b32 s3, s30, 1
    s_lshl_b32 s3, s3, 2
    s_lshr_b32 s7, s29, 3
    s_add_u32 s26, s3, s7
    s_lshl_b32 s5, s25, 16
    s_lshl_b32 s6, s26, 13
    s_add_u32 s6, s6, s5
    s_lshl_b32 s78, s24, 11
    s_add_u32 s6, s6, s78
    v_lshlrev_b32 v5, 4, v1
    v_xor_b32 v6, v3, v4
    v_lshlrev_b32 v6, 4, v6
    v_lshl_add_u32 v10, v2, 10, v6
    v_xor_b32 v11, 64, v10
    v_add_u32 v11, 7168, v11
    v_and_b32 v6, 1, v4
    v_lshlrev_b32 v6, 2, v6
    v_xor_b32 v6, v3, v6
    v_lshlrev_b32 v6, 4, v6
    v_mul_u32_u24 v7, 3072, v2
    v_add_u32 v12, v7, v6
    v_add_u32 v13, 24576, v12
    s_lshl_b32 s7, s24, 14
    s_add_u32 s32, s5, s7
    s_mul_i32 s33, s24, 49152
    s_lshl_b32 s7, s26, 7
    s_add_u32 s33, s33, s7
    s_mul_i32 s79, s24, 6144
    s_add_u32 s79, s79, 8192
    v_mov_b32 v9, 0
    s_mov_b32 s10, 2097152
    s_mov_b32 s11, 0x00020000
    s_mov_b32 s14, 1572864
    s_mov_b32 s15, 0x00020000
    s_mov_b32 s18, 16777216
    s_mov_b32 s19, 0x00020000
    s_waitcnt lgkmcnt(0)
    s_mov_b64 s[8:9], s[36:37]
    buffer_load_dwordx4 v[128:131], v5, s[8:11], s6 offen
    buffer_load_dwordx4 v[132:135], v5, s[8:11], s6 offen offset:1024
    global_load_dwordx4 v[136:139], v5, s[54:55]
    s_mov_b64 s[16:17], s[60:61]
    s_mov_b64 s[12:13], s[38:39]
    buffer_load_dwordx2 v[164:165], v9, s[16:19], 0 offen sc1
    s_and_b32 s34, s72, 7
    s_add_u32 m0, s78, 0
    s_lshl_b32 s4, s34, 7
    s_add_u32 s4, s4, s32
    buffer_load_dwordx4 v10, s[8:11], s4 offen lds
    buffer_load_dwordx4 v11, s[8:11], s4 offen offset:1024 lds
    s_add_u32 m0, s79, 0
    s_mul_i32 s4, s34, 196608
    s_add_u32 s4, s4, s33
    buffer_load_dwordx4 v12, s[12:15], s4 offen offset:0 lds
    buffer_load_dwordx4 v12, s[12:15], s4 offen offset:1024 lds
    buffer_load_dwordx4 v12, s[12:15], s4 offen offset:2048 lds
    v_mul_u32_u24 v7, 3584, v2
    v_add_u32 v14, v7, v6
    v_lshl_add_u32 v18, v2, 12, v6
    v_lshl_add_u32 v239, v2, 10, v6
    v_lshrrev_b32 v9, 5, v1
    s_mov_b32 s74, 1069066811
    s_lshr_b32 s3, s24, 1
    s_lshl_b32 s3, s3, 12
    v_and_b32 v6, 31, v1
    v_lshlrev_b32 v6, 7, v6
    v_bfe_u32 v7, v1, 1, 3
    v_xor_b32 v7, v7, v9
    v_lshl_add_u32 v6, v7, 4, v6
    v_add_u32 v24, s3, v6
    s_add_u32 m0, s79, 3072
    s_lshr_b32 s72, s72, 4
    buffer_load_dwordx4 v13, s[12:15], s4 offen offset:0 lds
    v_xor_b32 v25, 32, v24
    v_xor_b32 v26, 64, v24
    v_xor_b32 v27, 96, v24
    v_bfe_u32 v8, v1, 2, 2
    v_lshlrev_b32 v8, 7, v8
    v_bfe_u32 v7, v1, 4, 1
    v_lshl_add_u32 v8, v7, 5, v8
    v_and_b32 v7, 3, v1
    v_lshl_add_u32 v8, v7, 3, v8
    v_bfe_u32 v7, v1, 3, 1
    v_lshl_add_u32 v8, v7, 6, v8
    buffer_load_dwordx4 v13, s[12:15], s4 offen offset:1024 lds
    s_and_b32 s3, s24, 1
    s_lshl_b32 s3, s3, 6
    v_xor_b32 v7, s3, v8
    v_mul_u32_u24 v224, 3072, v9
    v_add_u32 v224, v224, v7
    v_add_u32 v224, 8192, v224
    buffer_load_dwordx4 v13, s[12:15], s4 offen offset:2048 lds
    s_mul_i32 s3, s24, 2176
    s_add_u32 s3, s3, 131072
    v_add_u32 v188, s3, v5
    v_bfe_u32 v6, v1, 2, 2
    v_mul_u32_u24 v6, 1088, v6
    v_lshl_add_u32 v6, v4, 5, v6
    v_and_b32 v7, 3, v1
    v_lshl_add_u32 v6, v7, 3, v6
    s_lshl_b32 s3, s24, 8
    s_add_u32 s3, s3, 131072
    v_add_u32 v189, s3, v6
    s_lshl_b32 s3, s25, 2
    s_lshr_b32 s7, s26, 1
    s_add_u32 s3, s3, s7
    s_lshl_b32 s3, s3, 11
    s_lshl_b32 s7, s24, 19
    s_add_u32 s3, s3, s7
    s_and_b32 s7, s26, 1
    s_lshl_b32 s7, s7, 9
    s_add_u32 s3, s3, s7
    s_add_u32 s76, s3, 1048576
    s_add_u32 s77, s76, 262144
    v_and_b32 v7, 31, v1
    v_lshlrev_b32 v7, 4, v7
    v_lshl_add_u32 v190, v9, 10, v7
    s_lshr_b32 s5, s6, 13
    s_lshl_b32 s5, s5, 7
    s_add_u32 s5, s5, 786432
    v_lshlrev_b32 v191, 2, v1
    s_lshl_b32 s3, s24, 3
    s_add_u32 s3, s3, 139776
    v_add_u32 v187, s3, v191
    v_add_u32 v186, 139776, v191
    s_and_b32 s3, s24, 1
    s_lshl_b32 s3, s3, 1
    s_lshl_b32 s7, s26, 2
    s_add_u32 s3, s3, s7
    s_lshl_b32 s3, s3, 9
    v_bfe_u32 v6, v1, 4, 1
    v_lshlrev_b32 v6, 9, v6
    v_and_b32 v7, 15, v1
    v_lshl_add_u32 v6, v7, 1, v6
    v_lshl_add_u32 v6, v9, 7, v6
    v_add_u32 v6, s3, v6
    global_load_ushort v200, v6, s[40:41] offset:0
    global_load_ushort v201, v6, s[40:41] offset:32
    global_load_ushort v202, v6, s[40:41] offset:64
    global_load_ushort v203, v6, s[40:41] offset:96
    global_load_ushort v204, v6, s[40:41] offset:256
    global_load_ushort v205, v6, s[40:41] offset:288
    global_load_ushort v206, v6, s[40:41] offset:320
    global_load_ushort v207, v6, s[40:41] offset:352
    s_waitcnt vmcnt(16)
    v_lshlrev_b32 v140, 16, v128
    v_and_b32 v141, 0xffff0000, v128
    v_lshlrev_b32 v142, 16, v129
    v_and_b32 v143, 0xffff0000, v129
    v_lshlrev_b32 v144, 16, v130
    v_and_b32 v145, 0xffff0000, v130
    v_lshlrev_b32 v146, 16, v131
    v_and_b32 v147, 0xffff0000, v131
    v_lshlrev_b32 v148, 16, v132
    v_and_b32 v149, 0xffff0000, v132
    v_lshlrev_b32 v150, 16, v133
    v_and_b32 v151, 0xffff0000, v133
    v_lshlrev_b32 v152, 16, v134
    v_and_b32 v153, 0xffff0000, v134
    v_lshlrev_b32 v154, 16, v135
    v_and_b32 v155, 0xffff0000, v135
    v_lshlrev_b32 v156, 16, v136
    v_and_b32 v157, 0xffff0000, v136
    v_lshlrev_b32 v158, 16, v137
    v_and_b32 v159, 0xffff0000, v137
    v_lshlrev_b32 v160, 16, v138
    v_and_b32 v161, 0xffff0000, v138
    v_lshlrev_b32 v162, 16, v139
    v_and_b32 v163, 0xffff0000, v139
    v_readfirstlane_b32 s62, v164
    v_readfirstlane_b32 s63, v165
    v_add_f32 v172, v140, v141
    v_add_f32 v173, v148, v149
    v_mul_f32 v174, v140, v156
    v_mul_f32 v175, v148, v156
    s_and_b32 s34, s72, 7
    s_add_u32 m0, s78, 32768
    s_lshl_b32 s4, s34, 7
    s_add_u32 s4, s4, s32
    buffer_load_dwordx4 v10, s[8:11], s4 offen lds
    s_mul_i32 s62, s62, 1664525
    s_add_u32 s62, s62, 1013904223
    s_mul_i32 s63, s63, 22695477
    s_add_u32 s63, s63, 1
    v_fmac_f32 v174, v141, v157
    v_fmac_f32 v175, v149, v157
    v_add_f32 v172, v172, v142
    v_add_f32 v173, v173, v150
    v_fmac_f32 v174, v142, v158
    v_fmac_f32 v175, v150, v158
    v_add_f32 v172, v172, v143
    v_add_f32 v173, v173, v151
    v_fmac_f32 v174, v143, v159
    v_fmac_f32 v175, v151, v159
    v_add_f32 v172, v172, v144
    v_add_f32 v173, v173, v152
    v_fmac_f32 v174, v144, v160
    v_fmac_f32 v175, v152, v160
    v_add_f32 v172, v172, v145
    v_add_f32 v173, v173, v153
    v_fmac_f32 v174, v145, v161
    v_fmac_f32 v175, v153, v161
    v_add_f32 v172, v172, v146
    v_add_f32 v173, v173, v154
    v_fmac_f32 v174, v146, v162
    v_fmac_f32 v175, v154, v162
    v_add_f32 v172, v172, v147
    v_add_f32 v173, v173, v155
    v_fmac_f32 v174, v147, v163
    v_fmac_f32 v175, v155, v163
    v_add_f32_dpp v172, v172, v172 row_ror:8 row_mask:0xf bank_mask:0xf
    v_add_f32_dpp v173, v173, v173 row_ror:8 row_mask:0xf bank_mask:0xf
    v_add_f32_dpp v174, v174, v174 row_ror:8 row_mask:0xf bank_mask:0xf
    v_add_f32_dpp v175, v175, v175 row_ror:8 row_mask:0xf bank_mask:0xf
    buffer_load_dwordx4 v11, s[8:11], s4 offen offset:1024 lds
    v_add_f32_dpp v172, v172, v172 row_ror:4 row_mask:0xf bank_mask:0xf
    v_add_f32_dpp v173, v173, v173 row_ror:4 row_mask:0xf bank_mask:0xf
    v_add_f32_dpp v174, v174, v174 row_ror:4 row_mask:0xf bank_mask:0xf
    v_add_f32_dpp v175, v175, v175 row_ror:4 row_mask:0xf bank_mask:0xf
    v_add_f32_dpp v172, v172, v172 row_ror:2 row_mask:0xf bank_mask:0xf
    v_add_f32_dpp v173, v173, v173 row_ror:2 row_mask:0xf bank_mask:0xf
    v_add_f32_dpp v174, v174, v174 row_ror:2 row_mask:0xf bank_mask:0xf
    v_add_f32_dpp v175, v175, v175 row_ror:2 row_mask:0xf bank_mask:0xf
    v_add_f32_dpp v172, v172, v172 row_ror:1 row_mask:0xf bank_mask:0xf
    v_add_f32_dpp v173, v173, v173 row_ror:1 row_mask:0xf bank_mask:0xf
    v_add_f32_dpp v174, v174, v174 row_ror:1 row_mask:0xf bank_mask:0xf
    v_add_f32_dpp v175, v175, v175 row_ror:1 row_mask:0xf bank_mask:0xf
    v_mov_b32 v176, v172
    v_mov_b32 v177, v173
    v_mov_b32 v178, v174
    v_mov_b32 v179, v175
    v_permlane16_swap_b32 v172, v176
    v_permlane16_swap_b32 v173, v177
    v_permlane16_swap_b32 v174, v178
    v_permlane16_swap_b32 v175, v179
    v_add_f32 v172, v172, v176
    v_add_f32 v173, v173, v177
    v_add_f32 v174, v174, v178
    v_add_f32 v175, v175, v179
    v_mov_b32 v176, v172
    v_mov_b32 v177, v173
    v_mov_b32 v178, v174
    v_mov_b32 v179, v175
    v_permlane32_swap_b32 v172, v176
    v_permlane32_swap_b32 v173, v177
    s_add_u32 m0, s79, 32768
    s_mul_i32 s4, s34, 196608
    s_add_u32 s4, s4, s33
    buffer_load_dwordx4 v12, s[12:15], s4 offen offset:0 lds
    v_permlane32_swap_b32 v174, v178
    v_permlane32_swap_b32 v175, v179
    v_add_f32 v172, v172, v176
    v_add_f32 v173, v173, v177
    v_add_f32 v174, v174, v178
    v_add_f32 v175, v175, v179
    v_mul_f32 v172, 0x3b000000, v172
    v_mul_f32 v173, 0x3b000000, v173
    v_sub_f32 v140, v140, v172
    v_sub_f32 v148, v148, v173
    v_sub_f32 v141, v141, v172
    v_sub_f32 v149, v149, v173
    v_sub_f32 v142, v142, v172
    v_sub_f32 v150, v150, v173
    v_sub_f32 v143, v143, v172
    v_sub_f32 v151, v151, v173
    v_sub_f32 v144, v144, v172
    v_sub_f32 v152, v152, v173
    v_sub_f32 v145, v145, v172
    v_sub_f32 v153, v153, v173
    v_sub_f32 v146, v146, v172
    v_sub_f32 v154, v154, v173
    v_sub_f32 v147, v147, v172
    v_sub_f32 v155, v155, v173
    v_mul_f32 v172, v140, v140
    v_mul_f32 v173, v148, v148
    v_fmac_f32 v172, v141, v141
    v_fmac_f32 v173, v149, v149
    v_fmac_f32 v172, v142, v142
    v_fmac_f32 v173, v150, v150
    buffer_load_dwordx4 v12, s[12:15], s4 offen offset:1024 lds
    v_fmac_f32 v172, v143, v143
    v_fmac_f32 v173, v151, v151
    v_fmac_f32 v172, v144, v144
    v_fmac_f32 v173, v152, v152
    v_fmac_f32 v172, v145, v145
    v_fmac_f32 v173, v153, v153
    v_fmac_f32 v172, v146, v146
    v_fmac_f32 v173, v154, v154
    v_fmac_f32 v172, v147, v147
    v_fmac_f32 v173, v155, v155
    v_cmp_eq_u32 vcc, 0, v1
    s_nop 1
    v_cndmask_b32 v174, v175, v174, vcc
    v_mul_f32 v174, s74, v174
    v_exp_f32 v174, -v174
    s_nop 0
    v_add_f32 v174, 1.0, v174
    v_rcp_f32 v174, v174
    v_add_f32_dpp v172, v172, v172 row_ror:8 row_mask:0xf bank_mask:0xf
    v_add_f32_dpp v173, v173, v173 row_ror:8 row_mask:0xf bank_mask:0xf
    s_nop 0
    v_add_f32_dpp v172, v172, v172 row_ror:4 row_mask:0xf bank_mask:0xf
    v_add_f32_dpp v173, v173, v173 row_ror:4 row_mask:0xf bank_mask:0xf
    s_nop 0
    v_add_f32_dpp v172, v172, v172 row_ror:2 row_mask:0xf bank_mask:0xf
    v_add_f32_dpp v173, v173, v173 row_ror:2 row_mask:0xf bank_mask:0xf
    s_nop 0
    v_add_f32_dpp v172, v172, v172 row_ror:1 row_mask:0xf bank_mask:0xf
    v_add_f32_dpp v173, v173, v173 row_ror:1 row_mask:0xf bank_mask:0xf
    v_mov_b32 v176, v172
    v_mov_b32 v177, v173
    s_nop 0
    v_permlane16_swap_b32 v172, v176
    v_permlane16_swap_b32 v173, v177
    buffer_load_dwordx4 v12, s[12:15], s4 offen offset:2048 lds
    v_add_f32 v172, v172, v176
    v_add_f32 v173, v173, v177
    v_mov_b32 v176, v172
    v_mov_b32 v177, v173
    s_nop 0
    v_permlane32_swap_b32 v172, v176
    v_permlane32_swap_b32 v173, v177
    v_add_f32 v172, v172, v176
    v_add_f32 v173, v173, v177
    v_mov_b32 v176, 0x3727c5ac
    v_fmamk_f32 v172, v172, 0x3b000000, v176
    v_fmamk_f32 v173, v173, 0x3b000000, v176
    v_rsq_f32 v172, v172
    v_rsq_f32 v173, v173
    v_mul_f32 v140, v172, v140
    v_mul_f32 v148, v173, v148
    v_mul_f32 v141, v172, v141
    v_mul_f32 v149, v173, v149
    v_mul_f32 v142, v172, v142
    v_mul_f32 v150, v173, v150
    v_mul_f32 v143, v172, v143
    v_mul_f32 v151, v173, v151
    v_mul_f32 v144, v172, v144
    v_mul_f32 v152, v173, v152
    v_mul_f32 v145, v172, v145
    v_mul_f32 v153, v173, v153
    v_mul_f32 v146, v172, v146
    v_mul_f32 v154, v173, v154
    v_mul_f32 v147, v172, v147
    s_add_u32 m0, s79, 35840
    s_lshr_b32 s72, s72, 4
    buffer_load_dwordx4 v13, s[12:15], s4 offen offset:0 lds
    v_mul_f32 v155, v173, v155
    v_cvt_pk_bf16_f32 v128, v140, v141
    v_cvt_pk_bf16_f32 v129, v142, v143
    v_cvt_pk_bf16_f32 v130, v144, v145
    v_cvt_pk_bf16_f32 v131, v146, v147
    v_cvt_pk_bf16_f32 v132, v148, v149
    v_cvt_pk_bf16_f32 v133, v150, v151
    v_cvt_pk_bf16_f32 v134, v152, v153
    v_cvt_pk_bf16_f32 v135, v154, v155
    ds_write_b128 v188, v[128:131]
    ds_write_b128 v188, v[132:135] offset:1088
    s_mov_b64 exec, 3
    ds_write_b32 v187, v174
    s_mov_b64 exec, -1
    s_waitcnt vmcnt(14) lgkmcnt(0)
    s_barrier
    ds_read_b64_tr_b16 v[128:129], v189
    ds_read_b64_tr_b16 v[130:131], v189 offset:4352
    ds_read_b64_tr_b16 v[132:133], v189 offset:128
    ds_read_b64_tr_b16 v[134:135], v189 offset:4480
    ds_read_b32 v136, v186
    ds_read_b128 v[32:35], v24 offset:0
    ds_read_b64_tr_b16 v[36:37], v224 offset:0
    ds_read_b64_tr_b16 v[38:39], v224 offset:512
    ds_read_b64_tr_b16 v[40:41], v224 offset:1024
    s_waitcnt lgkmcnt(4)
    s_cmp_lg_u32 s24, 0
    s_cbranch_scc1 L_ng_1
    s_mov_b64 exec, 0xff
    buffer_store_dword v136, v191, s[16:19], s5 offen sc1
    s_mov_b64 exec, -1
L_ng_1:
    buffer_store_dwordx4 v[128:131], v190, s[16:19], s76 offen sc1
    buffer_store_dwordx4 v[132:135], v190, s[16:19], s77 offen sc1
    buffer_load_dwordx4 v13, s[12:15], s4 offen offset:1024 lds
    ds_read_b64_tr_b16 v[42:43], v224 offset:1536
    ds_read_b64_tr_b16 v[44:45], v224 offset:2048
    ds_read_b64_tr_b16 v[46:47], v224 offset:2560
    buffer_load_dwordx4 v13, s[12:15], s4 offen offset:2048 lds
    s_and_b32 s34, s72, 7
    s_add_u32 m0, s78, 65536
    s_lshl_b32 s4, s34, 7
    s_add_u32 s4, s4, s32
    buffer_load_dwordx4 v10, s[8:11], s4 offen lds
    ds_read_b128 v[48:51], v25 offset:0
    ds_read_b64_tr_b16 v[52:53], v224 offset:6144
    ds_read_b64_tr_b16 v[54:55], v224 offset:6656
    buffer_load_dwordx4 v11, s[8:11], s4 offen offset:1024 lds
    ds_read_b64_tr_b16 v[56:57], v224 offset:7168
    ds_read_b64_tr_b16 v[58:59], v224 offset:7680
    s_and_b32 s3, s30, 1
    s_lshl_b32 s3, s3, 2
    s_and_b32 s7, s29, 3
    s_add_u32 s27, s3, s7
    s_lshr_b32 s3, s30, 1
    s_mul_i32 s7, s3, 7
    s_lshr_b32 s5, s29, 2
    s_add_u32 s28, s7, s5
    s_lshl_b32 s3, s3, 3
    s_add_u32 s31, s3, s5
    s_mov_b64 s[44:45], s[68:69]
    s_mov_b32 s35, s73
    v_add_u32 v15, 27648, v14
    v_add_u32 v16, 55296, v14
    v_add_u32 v17, 82944, v14
    s_add_u32 m0, s79, 65536
    s_mul_i32 s4, s34, 196608
    s_add_u32 s4, s4, s33
    buffer_load_dwordx4 v12, s[12:15], s4 offen offset:0 lds
    ds_read_b64_tr_b16 v[60:61], v224 offset:8192
    ds_read_b64_tr_b16 v[62:63], v224 offset:8704
    buffer_load_dwordx4 v12, s[12:15], s4 offen offset:1024 lds
    s_waitcnt lgkmcnt(7)
    v_mfma_f32_32x32x16_bf16 v[80:95], v[36:39], v[32:35], 0
    ds_read_b128 v[64:67], v26 offset:0
    ds_read_b64_tr_b16 v[68:69], v224 offset:12288
    ds_read_b64_tr_b16 v[70:71], v224 offset:12800
    buffer_load_dwordx4 v12, s[12:15], s4 offen offset:2048 lds
    v_mfma_f32_32x32x16_bf16 v[96:111], v[40:43], v[32:35], 0
    ds_read_b64_tr_b16 v[72:73], v224 offset:13312
    ds_read_b64_tr_b16 v[74:75], v224 offset:13824
    s_mul_i32 s58, s24, 1835008
    s_lshl_b32 s3, s28, 7
    s_add_u32 s58, s58, s3
    s_lshl_b32 s75, s24, 13
    s_mov_b32 s20, s46
    s_mov_b32 s21, s47
    s_mov_b32 s22, 7340032
    s_mov_b32 s23, 0x00020000
    s_cmp_ge_u32 s29, 28
    s_cselect_b32 s22, 0, s22
    s_lshl_b32 s3, s25, 3
    s_add_u32 s3, s3, s26
    s_lshl_b32 s3, s3, 7
    s_add_u32 s77, s3, 262144
    s_add_u32 m0, s79, 68608
    s_lshr_b32 s72, s72, 4
    buffer_load_dwordx4 v13, s[12:15], s4 offen offset:0 lds
    v_mfma_f32_32x32x16_bf16 v[112:127], v[32:35], v[44:47], 0
    ds_read_b64_tr_b16 v[76:77], v224 offset:14336
    ds_read_b64_tr_b16 v[78:79], v224 offset:14848
    buffer_load_dwordx4 v13, s[12:15], s4 offen offset:1024 lds
    s_waitcnt lgkmcnt(7)
    v_mfma_f32_32x32x16_bf16 v[80:95], v[52:55], v[48:51], v[80:95]
    ds_read_b128 v[32:35], v27 offset:0
    ds_read_b64_tr_b16 v[36:37], v224 offset:18432
    ds_read_b64_tr_b16 v[38:39], v224 offset:18944
    buffer_load_dwordx4 v13, s[12:15], s4 offen offset:2048 lds
    v_mfma_f32_32x32x16_bf16 v[96:111], v[56:59], v[48:51], v[96:111]
    ds_read_b64_tr_b16 v[40:41], v224 offset:19456
    ds_read_b64_tr_b16 v[42:43], v224 offset:19968
    v_add_u32 v28, 0x10000, v24
    v_add_u32 v29, 0x10000, v25
    v_add_u32 v30, 0x10000, v26
    v_add_u32 v31, 0x10000, v27
    v_add_u32 v225, 0x10000, v224
    v_mfma_f32_32x32x16_bf16 v[112:127], v[48:51], v[60:63], v[112:127]
    ds_read_b64_tr_b16 v[44:45], v224 offset:20480
    ds_read_b64_tr_b16 v[46:47], v224 offset:20992
    s_waitcnt lgkmcnt(7)
    v_mfma_f32_32x32x16_bf16 v[80:95], v[68:71], v[64:67], v[80:95]
    v_mfma_f32_32x32x16_bf16 v[96:111], v[72:75], v[64:67], v[96:111]
    s_waitcnt vmcnt(8) lgkmcnt(0)
    s_barrier
    ds_read_b128 v[48:51], v24 offset:32768
    ds_read_b64_tr_b16 v[52:53], v224 offset:32768
    ds_read_b64_tr_b16 v[54:55], v224 offset:33280
    ds_read_b64_tr_b16 v[56:57], v224 offset:33792
    s_and_b32 s34, s72, 7
    s_add_u32 m0, s78, 0
    s_lshl_b32 s4, s34, 7
    s_add_u32 s4, s4, s32
    buffer_load_dwordx4 v10, s[8:11], s4 offen lds
    v_mfma_f32_32x32x16_bf16 v[112:127], v[64:67], v[76:79], v[112:127]
    ds_read_b64_tr_b16 v[58:59], v224 offset:34304
    ds_read_b64_tr_b16 v[60:61], v224 offset:34816
    ds_read_b64_tr_b16 v[62:63], v224 offset:35328
    buffer_load_dwordx4 v11, s[8:11], s4 offen offset:1024 lds
    s_add_u32 m0, s79, 0
    s_mul_i32 s4, s34, 196608
    s_add_u32 s4, s4, s33
    buffer_load_dwordx4 v12, s[12:15], s4 offen offset:0 lds
    v_mfma_f32_32x32x16_bf16 v[80:95], v[36:39], v[32:35], v[80:95]
    ds_read_b128 v[64:67], v25 offset:32768
    ds_read_b64_tr_b16 v[68:69], v224 offset:38912
    ds_read_b64_tr_b16 v[70:71], v224 offset:39424
    buffer_load_dwordx4 v12, s[12:15], s4 offen offset:1024 lds
    v_mfma_f32_32x32x16_bf16 v[96:111], v[40:43], v[32:35], v[96:111]
    ds_read_b64_tr_b16 v[72:73], v224 offset:39936
    ds_read_b64_tr_b16 v[74:75], v224 offset:40448
    buffer_load_dwordx4 v12, s[12:15], s4 offen offset:2048 lds
    v_mfma_f32_32x32x16_bf16 v[112:127], v[32:35], v[44:47], v[112:127]
    ds_read_b64_tr_b16 v[76:77], v224 offset:40960
    ds_read_b64_tr_b16 v[78:79], v224 offset:41472
    s_add_u32 m0, s79, 3072
    s_lshr_b32 s72, s72, 4
    buffer_load_dwordx4 v13, s[12:15], s4 offen offset:0 lds
    s_waitcnt lgkmcnt(7)
    v_mfma_f32_32x32x16_bf16 v[80:95], v[52:55], v[48:51], v[80:95]
    ds_read_b128 v[32:35], v26 offset:32768
    ds_read_b64_tr_b16 v[36:37], v224 offset:45056
    ds_read_b64_tr_b16 v[38:39], v224 offset:45568
    buffer_load_dwordx4 v13, s[12:15], s4 offen offset:1024 lds
    v_mfma_f32_32x32x16_bf16 v[96:111], v[56:59], v[48:51], v[96:111]
    ds_read_b64_tr_b16 v[40:41], v224 offset:46080
    ds_read_b64_tr_b16 v[42:43], v224 offset:46592
    s_lshl_b32 s59, s24, 16
    s_lshl_b32 s3, s27, 18
    s_add_u32 s59, s59, s3
    s_add_u32 s59, s59, 1048576
    s_mov_b32 s64, s60
    s_mov_b32 s65, s61
    s_mov_b32 s66, 16777216
    s_mov_b32 s67, 0x00020000
    s_cmp_ge_u32 s29, 28
    s_cselect_b32 s66, 0, s66
    s_mov_b32 s36, 0x0000ffff
    s_mov_b32 s37, 0x0000ffff
    s_and_b32 s3, s24, 1
    s_lshl_b32 s3, s3, 10
    v_add_u32 v22, s3, v5
    v_xor_b32 v23, 0x400, v22
    buffer_load_dwordx4 v13, s[12:15], s4 offen offset:2048 lds
    v_mfma_f32_32x32x16_bf16 v[112:127], v[48:51], v[60:63], v[112:127]
    ds_read_b64_tr_b16 v[44:45], v224 offset:47104
    ds_read_b64_tr_b16 v[46:47], v224 offset:47616
    s_and_b32 s4, s68, 15
    s_lshr_b64 s[68:69], s[68:69], 4
    s_add_u32 m0, s75, 98304
    s_mul_i32 s4, s4, 114688
    s_add_u32 s4, s4, s58
    buffer_load_dwordx4 v14, s[20:23], s4 offen offset:0 lds
    s_waitcnt lgkmcnt(7)
    v_mfma_f32_32x32x16_bf16 v[80:95], v[68:71], v[64:67], v[80:95]
    ds_read_b128 v[48:51], v27 offset:32768
    ds_read_b64_tr_b16 v[52:53], v224 offset:51200
    ds_read_b64_tr_b16 v[54:55], v224 offset:51712
    buffer_load_dwordx4 v15, s[20:23], s4 offen offset:1024 lds
    v_mfma_f32_32x32x16_bf16 v[96:111], v[72:75], v[64:67], v[96:111]
    ds_read_b64_tr_b16 v[56:57], v224 offset:52224
    ds_read_b64_tr_b16 v[58:59], v224 offset:52736
    buffer_load_dwordx4 v16, s[20:23], s4 offen offset:2048 lds
    v_mfma_f32_32x32x16_bf16 v[112:127], v[64:67], v[76:79], v[112:127]
    ds_read_b64_tr_b16 v[60:61], v224 offset:53248
    ds_read_b64_tr_b16 v[62:63], v224 offset:53760
    buffer_load_dwordx4 v17, s[20:23], s4 offen offset:3072 lds
    s_waitcnt lgkmcnt(7)
    v_mfma_f32_32x32x16_bf16 v[80:95], v[36:39], v[32:35], v[80:95]
    v_mfma_f32_32x32x16_bf16 v[96:111], v[40:43], v[32:35], v[96:111]
    s_waitcnt vmcnt(12) lgkmcnt(0)
    s_barrier
    ds_read_b128 v[64:67], v28 offset:0
    ds_read_b64_tr_b16 v[68:69], v225 offset:0
    ds_read_b64_tr_b16 v[70:71], v225 offset:512
    ds_read_b64_tr_b16 v[72:73], v225 offset:1024
    s_and_b32 s34, s72, 7
    s_add_u32 m0, s78, 32768
    s_lshl_b32 s4, s34, 7
    s_add_u32 s4, s4, s32
    buffer_load_dwordx4 v10, s[8:11], s4 offen lds
    v_mfma_f32_32x32x16_bf16 v[112:127], v[32:35], v[44:47], v[112:127]
    ds_read_b64_tr_b16 v[74:75], v225 offset:1536
    ds_read_b64_tr_b16 v[76:77], v225 offset:2048
    ds_read_b64_tr_b16 v[78:79], v225 offset:2560
    buffer_load_dwordx4 v11, s[8:11], s4 offen offset:1024 lds
    s_add_u32 m0, s79, 32768
    s_mul_i32 s4, s34, 196608
    s_add_u32 s4, s4, s33
    buffer_load_dwordx4 v12, s[12:15], s4 offen offset:0 lds
    s_cmp_lg_u32 s24, 0
    s_cbranch_scc1 L_nf_2
    v_mov_b32 v2, s62
    v_mov_b32 v3, s63
    v_mov_b32 v4, 0
    s_mov_b64 exec, 1
    buffer_store_dwordx2 v[2:3], v4, s[16:19], s77 offen sc1
    s_mov_b64 exec, -1
L_nf_2:
    s_nop 3
    v_mfma_f32_32x32x16_bf16 v[80:95], v[52:55], v[48:51], v[80:95]
    ds_read_b128 v[32:35], v29 offset:0
    ds_read_b64_tr_b16 v[36:37], v225 offset:6144
    ds_read_b64_tr_b16 v[38:39], v225 offset:6656
    buffer_load_dwordx4 v12, s[12:15], s4 offen offset:1024 lds
    v_mfma_f32_32x32x16_bf16 v[96:111], v[56:59], v[48:51], v[96:111]
    ds_read_b64_tr_b16 v[40:41], v225 offset:7168
    ds_read_b64_tr_b16 v[42:43], v225 offset:7680
    s_lshr_b32 s3, s24, 1
    s_lshl_b32 s3, s3, 6
    v_xor_b32 v7, s3, v8
    v_lshl_add_u32 v7, v9, 10, v7
    v_add_u32 v226, s75, v7
    v_xor_b32 v227, 64, v226
    v_add_u32 v228, 0x10000, v226
    v_add_u32 v229, 0x10000, v227
    v_add_u32 v230, 0x20000, v226
    v_add_u32 v231, 0x20000, v227
    buffer_load_dwordx4 v12, s[12:15], s4 offen offset:2048 lds
    v_mfma_f32_32x32x16_bf16 v[112:127], v[48:51], v[60:63], v[112:127]
    ds_read_b64_tr_b16 v[44:45], v225 offset:8192
    ds_read_b64_tr_b16 v[46:47], v225 offset:8704
    s_add_u32 m0, s79, 35840
    s_lshr_b32 s72, s72, 4
    buffer_load_dwordx4 v13, s[12:15], s4 offen offset:0 lds
    s_waitcnt lgkmcnt(7)
    v_mfma_f32_32x32x16_bf16 v[80:95], v[68:71], v[64:67], v[80:95]
    ds_read_b128 v[48:51], v30 offset:0
    ds_read_b64_tr_b16 v[52:53], v225 offset:12288
    ds_read_b64_tr_b16 v[54:55], v225 offset:12800
    buffer_load_dwordx4 v13, s[12:15], s4 offen offset:1024 lds
    v_mfma_f32_32x32x16_bf16 v[96:111], v[72:75], v[64:67], v[96:111]
    ds_read_b64_tr_b16 v[56:57], v225 offset:13312
    ds_read_b64_tr_b16 v[58:59], v225 offset:13824
    v_add_u32 v19, 31744, v18
    v_add_u32 v20, 63488, v18
    v_add_u32 v21, 95232, v18
    v_and_b32 v6, 31, v1
    v_lshlrev_b32 v7, 2, v9
    v_sub_u32 v192, v6, v7
    v_mov_b32 v193, 0x3f80
    v_mov_b32 v194, 0x3f800000
    buffer_load_dwordx4 v13, s[12:15], s4 offen offset:2048 lds
    v_mfma_f32_32x32x16_bf16 v[112:127], v[64:67], v[76:79], v[112:127]
    ds_read_b64_tr_b16 v[60:61], v225 offset:14336
    ds_read_b64_tr_b16 v[62:63], v225 offset:14848
    s_and_b32 s4, s68, 15
    s_lshr_b64 s[68:69], s[68:69], 4
    s_add_u32 m0, s75, 102400
    s_mul_i32 s4, s4, 114688
    s_add_u32 s4, s4, s58
    buffer_load_dwordx4 v14, s[20:23], s4 offen offset:0 lds
    s_waitcnt lgkmcnt(7)
    v_mfma_f32_32x32x16_bf16 v[80:95], v[36:39], v[32:35], v[80:95]
    ds_read_b128 v[64:67], v31 offset:0
    ds_read_b64_tr_b16 v[68:69], v225 offset:18432
    ds_read_b64_tr_b16 v[70:71], v225 offset:18944
    buffer_load_dwordx4 v15, s[20:23], s4 offen offset:1024 lds
    v_mfma_f32_32x32x16_bf16 v[96:111], v[40:43], v[32:35], v[96:111]
    ds_read_b64_tr_b16 v[72:73], v225 offset:19456
    ds_read_b64_tr_b16 v[74:75], v225 offset:19968
    buffer_load_dwordx4 v16, s[20:23], s4 offen offset:2048 lds
    v_mfma_f32_32x32x16_bf16 v[112:127], v[32:35], v[44:47], v[112:127]
    ds_read_b64_tr_b16 v[76:77], v225 offset:20480
    ds_read_b64_tr_b16 v[78:79], v225 offset:20992
    buffer_load_dwordx4 v17, s[20:23], s4 offen offset:3072 lds
    s_waitcnt lgkmcnt(7)
    v_mfma_f32_32x32x16_bf16 v[80:95], v[52:55], v[48:51], v[80:95]
    v_mfma_f32_32x32x16_bf16 v[96:111], v[56:59], v[48:51], v[96:111]
    s_waitcnt vmcnt(16) lgkmcnt(0)
    s_barrier
    ds_read_b128 v[32:35], v24 offset:0
    ds_read_b64_tr_b16 v[36:37], v224 offset:0
    ds_read_b64_tr_b16 v[38:39], v224 offset:512
    ds_read_b64_tr_b16 v[40:41], v224 offset:1024
    s_and_b32 s34, s72, 7
    s_add_u32 m0, s78, 65536
    s_lshl_b32 s4, s34, 7
    s_add_u32 s4, s4, s32
    buffer_load_dwordx4 v10, s[8:11], s4 offen lds
    v_mfma_f32_32x32x16_bf16 v[112:127], v[48:51], v[60:63], v[112:127]
    ds_read_b64_tr_b16 v[42:43], v224 offset:1536
    ds_read_b64_tr_b16 v[44:45], v224 offset:2048
    ds_read_b64_tr_b16 v[46:47], v224 offset:2560
    buffer_load_dwordx4 v11, s[8:11], s4 offen offset:1024 lds
    s_add_u32 m0, s79, 65536
    s_mul_i32 s4, s34, 196608
    s_add_u32 s4, s4, s33
    buffer_load_dwordx4 v12, s[12:15], s4 offen offset:0 lds
    v_mfma_f32_32x32x16_bf16 v[80:95], v[68:71], v[64:67], v[80:95]
    ds_read_b128 v[48:51], v25 offset:0
    ds_read_b64_tr_b16 v[52:53], v224 offset:6144
    ds_read_b64_tr_b16 v[54:55], v224 offset:6656
    buffer_load_dwordx4 v12, s[12:15], s4 offen offset:1024 lds
    v_mfma_f32_32x32x16_bf16 v[96:111], v[72:75], v[64:67], v[96:111]
    ds_read_b64_tr_b16 v[56:57], v224 offset:7168
    ds_read_b64_tr_b16 v[58:59], v224 offset:7680
    v_cmp_eq_u32 vcc, 0, v192
    v_cmp_eq_u32 s[38:39], 1, v192
    s_nop 0
    v_cndmask_b32 v216, 0, v193, vcc
    v_cndmask_b32 v216, v216, v194, s[38:39]
    v_cmp_eq_u32 vcc, 2, v192
    v_cmp_eq_u32 s[38:39], 3, v192
    s_nop 0
    v_cndmask_b32 v217, 0, v193, vcc
    v_cndmask_b32 v217, v217, v194, s[38:39]
    v_cmp_eq_u32 vcc, 8, v192
    v_cmp_eq_u32 s[38:39], 9, v192
    s_nop 0
    v_cndmask_b32 v218, 0, v193, vcc
    v_cndmask_b32 v218, v218, v194, s[38:39]
    v_cmp_eq_u32 vcc, 10, v192
    v_cmp_eq_u32 s[38:39], 11, v192
    s_nop 0
    v_cndmask_b32 v219, 0, v193, vcc
    v_cndmask_b32 v219, v219, v194, s[38:39]
    buffer_load_dwordx4 v12, s[12:15], s4 offen offset:2048 lds
    v_mfma_f32_32x32x16_bf16 v[112:127], v[64:67], v[76:79], v[112:127]
    ds_read_b64_tr_b16 v[60:61], v224 offset:8192
    ds_read_b64_tr_b16 v[62:63], v224 offset:8704
    s_add_u32 m0, s79, 68608
    s_lshr_b32 s72, s72, 4
    buffer_load_dwordx4 v13, s[12:15], s4 offen offset:0 lds
    s_waitcnt lgkmcnt(7)
    v_mfma_f32_32x32x16_bf16 v[80:95], v[36:39], v[32:35], v[80:95]
    ds_read_b128 v[64:67], v26 offset:0
    ds_read_b64_tr_b16 v[68:69], v224 offset:12288
    ds_read_b64_tr_b16 v[70:71], v224 offset:12800
    buffer_load_dwordx4 v13, s[12:15], s4 offen offset:1024 lds
    v_mfma_f32_32x32x16_bf16 v[96:111], v[40:43], v[32:35], v[96:111]
    ds_read_b64_tr_b16 v[72:73], v224 offset:13312
    ds_read_b64_tr_b16 v[74:75], v224 offset:13824
    v_cmp_eq_u32 vcc, 16, v192
    v_cmp_eq_u32 s[38:39], 17, v192
    s_nop 0
    v_cndmask_b32 v220, 0, v193, vcc
    v_cndmask_b32 v220, v220, v194, s[38:39]
    v_cmp_eq_u32 vcc, 18, v192
    v_cmp_eq_u32 s[38:39], 19, v192
    s_nop 0
    v_cndmask_b32 v221, 0, v193, vcc
    v_cndmask_b32 v221, v221, v194, s[38:39]
    v_cmp_eq_u32 vcc, 24, v192
    v_cmp_eq_u32 s[38:39], 25, v192
    s_nop 0
    v_cndmask_b32 v222, 0, v193, vcc
    v_cndmask_b32 v222, v222, v194, s[38:39]
    v_cmp_eq_u32 vcc, 26, v192
    v_cmp_eq_u32 s[38:39], 27, v192
    s_nop 0
    v_cndmask_b32 v223, 0, v193, vcc
    v_cndmask_b32 v223, v223, v194, s[38:39]
    buffer_load_dwordx4 v13, s[12:15], s4 offen offset:2048 lds
    v_mfma_f32_32x32x16_bf16 v[112:127], v[32:35], v[44:47], v[112:127]
    ds_read_b64_tr_b16 v[76:77], v224 offset:14336
    ds_read_b64_tr_b16 v[78:79], v224 offset:14848
    s_and_b32 s4, s68, 15
    s_lshr_b64 s[68:69], s[68:69], 4
    s_add_u32 m0, s75, 131072
    s_mul_i32 s4, s4, 114688
    s_add_u32 s4, s4, s58
    buffer_load_dwordx4 v14, s[20:23], s4 offen offset:0 lds
    s_waitcnt lgkmcnt(7)
    v_mfma_f32_32x32x16_bf16 v[80:95], v[52:55], v[48:51], v[80:95]
    ds_read_b128 v[32:35], v27 offset:0
    ds_read_b64_tr_b16 v[36:37], v224 offset:18432
    ds_read_b64_tr_b16 v[38:39], v224 offset:18944
    buffer_load_dwordx4 v15, s[20:23], s4 offen offset:1024 lds
    v_mfma_f32_32x32x16_bf16 v[96:111], v[56:59], v[48:51], v[96:111]
    ds_read_b64_tr_b16 v[40:41], v224 offset:19456
    ds_read_b64_tr_b16 v[42:43], v224 offset:19968
    buffer_load_dwordx4 v16, s[20:23], s4 offen offset:2048 lds
    v_mfma_f32_32x32x16_bf16 v[112:127], v[48:51], v[60:63], v[112:127]
    ds_read_b64_tr_b16 v[44:45], v224 offset:20480
    ds_read_b64_tr_b16 v[46:47], v224 offset:20992
    buffer_load_dwordx4 v17, s[20:23], s4 offen offset:3072 lds
    s_waitcnt lgkmcnt(7)
    v_mfma_f32_32x32x16_bf16 v[80:95], v[68:71], v[64:67], v[80:95]
    v_mfma_f32_32x32x16_bf16 v[96:111], v[72:75], v[64:67], v[96:111]
    s_waitcnt vmcnt(16) lgkmcnt(0)
    s_barrier
    ds_read_b128 v[48:51], v24 offset:32768
    ds_read_b64_tr_b16 v[52:53], v224 offset:32768
    ds_read_b64_tr_b16 v[54:55], v224 offset:33280
    ds_read_b64_tr_b16 v[56:57], v224 offset:33792
    s_and_b32 s34, s72, 7
    s_add_u32 m0, s78, 0
    s_lshl_b32 s4, s34, 7
    s_add_u32 s4, s4, s32
    buffer_load_dwordx4 v10, s[8:11], s4 offen lds
    v_mfma_f32_32x32x16_bf16 v[112:127], v[64:67], v[76:79], v[112:127]
    ds_read_b64_tr_b16 v[58:59], v224 offset:34304
    ds_read_b64_tr_b16 v[60:61], v224 offset:34816
    ds_read_b64_tr_b16 v[62:63], v224 offset:35328
    buffer_load_dwordx4 v11, s[8:11], s4 offen offset:1024 lds
    s_add_u32 m0, s79, 0
    s_mul_i32 s4, s34, 196608
    s_add_u32 s4, s4, s33
    buffer_load_dwordx4 v12, s[12:15], s4 offen offset:0 lds
    v_mfma_f32_32x32x16_bf16 v[80:95], v[36:39], v[32:35], v[80:95]
    ds_read_b128 v[64:67], v25 offset:32768
    ds_read_b64_tr_b16 v[68:69], v224 offset:38912
    ds_read_b64_tr_b16 v[70:71], v224 offset:39424
    buffer_load_dwordx4 v12, s[12:15], s4 offen offset:1024 lds
    v_mfma_f32_32x32x16_bf16 v[96:111], v[40:43], v[32:35], v[96:111]
    ds_read_b64_tr_b16 v[72:73], v224 offset:39936
    ds_read_b64_tr_b16 v[74:75], v224 offset:40448
    v_lshl_or_b32 v168, v201, 16, v200
    v_lshl_or_b32 v169, v203, 16, v202
    v_lshl_or_b32 v170, v205, 16, v204
    v_lshl_or_b32 v171, v207, 16, v206
    v_cndmask_b32 v248, 0, v168, s[36:37]
    v_cndmask_b32 v252, v168, 0, s[36:37]
    v_cndmask_b32 v249, 0, v169, s[36:37]
    v_cndmask_b32 v253, v169, 0, s[36:37]
    v_cndmask_b32 v250, 0, v170, s[36:37]
    v_cndmask_b32 v254, v170, 0, s[36:37]
    v_cndmask_b32 v251, 0, v171, s[36:37]
    v_cndmask_b32 v255, v171, 0, s[36:37]
    buffer_load_dwordx4 v12, s[12:15], s4 offen offset:2048 lds
    v_mfma_f32_32x32x16_bf16 v[112:127], v[32:35], v[44:47], v[112:127]
    ds_read_b64_tr_b16 v[76:77], v224 offset:40960
    ds_read_b64_tr_b16 v[78:79], v224 offset:41472
    s_add_u32 m0, s79, 3072
    s_lshr_b32 s72, s72, 4
    buffer_load_dwordx4 v13, s[12:15], s4 offen offset:0 lds
    s_waitcnt lgkmcnt(7)
    v_mfma_f32_32x32x16_bf16 v[80:95], v[52:55], v[48:51], v[80:95]
    ds_read_b128 v[32:35], v26 offset:32768
    ds_read_b64_tr_b16 v[36:37], v224 offset:45056
    ds_read_b64_tr_b16 v[38:39], v224 offset:45568
    buffer_load_dwordx4 v13, s[12:15], s4 offen offset:1024 lds
    v_mfma_f32_32x32x16_bf16 v[96:111], v[56:59], v[48:51], v[96:111]
    ds_read_b64_tr_b16 v[40:41], v224 offset:46080
    ds_read_b64_tr_b16 v[42:43], v224 offset:46592
    s_and_b32 s3, s24, 1
    s_lshl_b32 s7, s26, 1
    s_add_u32 s3, s3, s7
    s_lshl_b32 s3, s3, 5
    s_add_u32 s3, s3, s25
    s_lshr_b32 s5, s24, 1
    s_lshl_b32 s7, s3, 1
    s_add_u32 s7, s7, s5
    s_lshl_b32 s7, s7, 7
    s_add_u32 s77, s7, 393216
    s_mul_i32 s3, s3, 4608
    s_add_u32 s76, s3, 3149824
    s_lshl_b32 s7, s5, 8
    s_add_u32 s7, s7, 4096
    v_lshl_add_u32 v232, v1, 2, s7
    s_xor_b32 s3, s24, 2
    s_lshl_b32 s3, s3, 13
    v_add_u32 v233, s3, v5
    v_add_u32 v234, s75, v5
    buffer_load_dwordx4 v13, s[12:15], s4 offen offset:2048 lds
    v_mfma_f32_32x32x16_bf16 v[112:127], v[48:51], v[60:63], v[112:127]
    ds_read_b64_tr_b16 v[44:45], v224 offset:47104
    ds_read_b64_tr_b16 v[46:47], v224 offset:47616
    s_and_b32 s4, s68, 15
    s_lshr_b64 s[68:69], s[68:69], 4
    s_add_u32 m0, s75, 135168
    s_mul_i32 s4, s4, 114688
    s_add_u32 s4, s4, s58
    buffer_load_dwordx4 v14, s[20:23], s4 offen offset:0 lds
    s_waitcnt lgkmcnt(7)
    v_mfma_f32_32x32x16_bf16 v[80:95], v[68:71], v[64:67], v[80:95]
    ds_read_b128 v[48:51], v27 offset:32768
    ds_read_b64_tr_b16 v[52:53], v224 offset:51200
    ds_read_b64_tr_b16 v[54:55], v224 offset:51712
    buffer_load_dwordx4 v15, s[20:23], s4 offen offset:1024 lds
    v_mfma_f32_32x32x16_bf16 v[96:111], v[72:75], v[64:67], v[96:111]
    ds_read_b64_tr_b16 v[56:57], v224 offset:52224
    ds_read_b64_tr_b16 v[58:59], v224 offset:52736
    buffer_load_dwordx4 v16, s[20:23], s4 offen offset:2048 lds
    v_mfma_f32_32x32x16_bf16 v[112:127], v[64:67], v[76:79], v[112:127]
    ds_read_b64_tr_b16 v[60:61], v224 offset:53248
    ds_read_b64_tr_b16 v[62:63], v224 offset:53760
    buffer_load_dwordx4 v17, s[20:23], s4 offen offset:3072 lds
    v_lshlrev_b32 v238, 7, v0
    v_add_u32 v238, 262144, v238
    buffer_load_dwordx2 v[236:237], v238, s[16:19], 0 offen sc1
    s_waitcnt lgkmcnt(7)
    v_mfma_f32_32x32x16_bf16 v[80:95], v[36:39], v[32:35], v[80:95]
    v_mfma_f32_32x32x16_bf16 v[96:111], v[40:43], v[32:35], v[96:111]
    s_waitcnt vmcnt(17) lgkmcnt(0)
    s_barrier
    ds_read_b128 v[64:67], v28 offset:0
    ds_read_b64_tr_b16 v[68:69], v225 offset:0
    ds_read_b64_tr_b16 v[70:71], v225 offset:512
    ds_read_b64_tr_b16 v[72:73], v225 offset:1024
    s_and_b32 s34, s72, 7
    s_add_u32 m0, s78, 32768
    s_lshl_b32 s4, s34, 7
    s_add_u32 s4, s4, s32
    buffer_load_dwordx4 v10, s[8:11], s4 offen lds
    v_mfma_f32_32x32x16_bf16 v[112:127], v[32:35], v[44:47], v[112:127]
    ds_read_b64_tr_b16 v[74:75], v225 offset:1536
    ds_read_b64_tr_b16 v[76:77], v225 offset:2048
    ds_read_b64_tr_b16 v[78:79], v225 offset:2560
    buffer_load_dwordx4 v11, s[8:11], s4 offen offset:1024 lds
    v_mfma_f32_32x32x16_bf16 v[80:95], v[52:55], v[48:51], v[80:95]
    ds_read_b128 v[32:35], v29 offset:0
    ds_read_b64_tr_b16 v[36:37], v225 offset:6144
    ds_read_b64_tr_b16 v[38:39], v225 offset:6656
    s_add_u32 m0, s79, 32768
    s_mul_i32 s4, s34, 196608
    s_add_u32 s4, s4, s33
    buffer_load_dwordx4 v12, s[12:15], s4 offen offset:0 lds
    v_mfma_f32_32x32x16_bf16 v[96:111], v[56:59], v[48:51], v[96:111]
    ds_read_b64_tr_b16 v[40:41], v225 offset:7168
    ds_read_b64_tr_b16 v[42:43], v225 offset:7680
    v_mfma_f32_32x32x16_bf16 v[112:127], v[48:51], v[60:63], v[112:127]
    ds_read_b64_tr_b16 v[44:45], v225 offset:8192
    ds_read_b64_tr_b16 v[46:47], v225 offset:8704
    buffer_load_dwordx4 v12, s[12:15], s4 offen offset:1024 lds
    s_waitcnt lgkmcnt(7)
    v_mfma_f32_32x32x16_bf16 v[80:95], v[68:71], v[64:67], v[80:95]
    ds_read_b128 v[48:51], v30 offset:0
    ds_read_b64_tr_b16 v[52:53], v225 offset:12288
    ds_read_b64_tr_b16 v[54:55], v225 offset:12800
    buffer_load_dwordx4 v12, s[12:15], s4 offen offset:2048 lds
    v_mfma_f32_32x32x16_bf16 v[96:111], v[72:75], v[64:67], v[96:111]
    ds_read_b64_tr_b16 v[56:57], v225 offset:13312
    ds_read_b64_tr_b16 v[58:59], v225 offset:13824
    v_mfma_f32_32x32x16_bf16 v[112:127], v[64:67], v[76:79], v[112:127]
    ds_read_b64_tr_b16 v[60:61], v225 offset:14336
    ds_read_b64_tr_b16 v[62:63], v225 offset:14848
    s_add_u32 m0, s79, 35840
    s_lshr_b32 s72, s72, 4
    buffer_load_dwordx4 v13, s[12:15], s4 offen offset:0 lds
    s_waitcnt lgkmcnt(7)
    v_mfma_f32_32x32x16_bf16 v[80:95], v[36:39], v[32:35], v[80:95]
    ds_read_b128 v[64:67], v31 offset:0
    ds_read_b64_tr_b16 v[68:69], v225 offset:18432
    ds_read_b64_tr_b16 v[70:71], v225 offset:18944
    buffer_load_dwordx4 v13, s[12:15], s4 offen offset:1024 lds
    v_mfma_f32_32x32x16_bf16 v[96:111], v[40:43], v[32:35], v[96:111]
    ds_read_b64_tr_b16 v[72:73], v225 offset:19456
    ds_read_b64_tr_b16 v[74:75], v225 offset:19968
    v_mfma_f32_32x32x16_bf16 v[112:127], v[32:35], v[44:47], v[112:127]
    ds_read_b64_tr_b16 v[76:77], v225 offset:20480
    ds_read_b64_tr_b16 v[78:79], v225 offset:20992
    buffer_load_dwordx4 v13, s[12:15], s4 offen offset:2048 lds
    s_waitcnt lgkmcnt(7)
    v_mfma_f32_32x32x16_bf16 v[80:95], v[52:55], v[48:51], v[80:95]
    v_mfma_f32_32x32x16_bf16 v[96:111], v[56:59], v[48:51], v[96:111]
    s_waitcnt vmcnt(13) lgkmcnt(0)
    s_barrier
    ds_read_b128 v[32:35], v24 offset:0
    ds_read_b64_tr_b16 v[36:37], v224 offset:0
    ds_read_b64_tr_b16 v[38:39], v224 offset:512
    ds_read_b64_tr_b16 v[40:41], v224 offset:1024
    s_and_b32 s4, s68, 15
    s_lshr_b64 s[68:69], s[68:69], 4
    s_add_u32 m0, s75, 65536
    s_mul_i32 s4, s4, 114688
    s_add_u32 s4, s4, s58
    buffer_load_dwordx4 v14, s[20:23], s4 offen offset:0 lds
    v_mfma_f32_32x32x16_bf16 v[112:127], v[48:51], v[60:63], v[112:127]
    ds_read_b64_tr_b16 v[42:43], v224 offset:1536
    ds_read_b64_tr_b16 v[44:45], v224 offset:2048
    ds_read_b64_tr_b16 v[46:47], v224 offset:2560
    buffer_load_dwordx4 v15, s[20:23], s4 offen offset:1024 lds
    s_waitcnt vmcnt(10)
    v_cmp_ne_u64 vcc, s[62:63], v[236:237]
    s_nop 4
    s_cbranch_vccz L_ok_3
    s_mov_b32 s3, 50000
L_spin_4:
    s_sleep 2
    buffer_load_dwordx2 v[236:237], v238, s[16:19], 0 offen sc1
    s_waitcnt vmcnt(0)
    v_cmp_ne_u64 vcc, s[62:63], v[236:237]
    s_sub_u32 s3, s3, 1
    s_cmp_eq_u32 s3, 0
    s_cbranch_scc1 L_ok_3
    s_nop 2
    s_cbranch_vccnz L_spin_4
L_ok_3:
    v_mfma_f32_32x32x16_bf16 v[80:95], v[68:71], v[64:67], v[80:95]
    ds_read_b128 v[48:51], v25 offset:0
    ds_read_b64_tr_b16 v[52:53], v224 offset:6144
    ds_read_b64_tr_b16 v[54:55], v224 offset:6656
    buffer_load_dwordx4 v16, s[20:23], s4 offen offset:2048 lds
    v_mfma_f32_32x32x16_bf16 v[96:111], v[72:75], v[64:67], v[96:111]
    ds_read_b64_tr_b16 v[56:57], v224 offset:7168
    ds_read_b64_tr_b16 v[58:59], v224 offset:7680
    v_mfma_f32_32x32x16_bf16 v[112:127], v[64:67], v[76:79], v[112:127]
    ds_read_b64_tr_b16 v[60:61], v224 offset:8192
    ds_read_b64_tr_b16 v[62:63], v224 offset:8704
    buffer_load_dwordx4 v17, s[20:23], s4 offen offset:3072 lds
    s_waitcnt lgkmcnt(7)
    v_mfma_f32_32x32x16_bf16 v[80:95], v[36:39], v[32:35], v[80:95]
    ds_read_b128 v[64:67], v26 offset:0
    ds_read_b64_tr_b16 v[68:69], v224 offset:12288
    ds_read_b64_tr_b16 v[70:71], v224 offset:12800
    s_and_b32 s4, s44, 15
    s_lshr_b64 s[44:45], s[44:45], 4
    s_lshl_b32 s4, s4, 12
    s_add_u32 s4, s4, s59
    buffer_load_dwordx4 a[0:3], v22, s[64:67], s4 offen offset:0 sc1
    v_mfma_f32_32x32x16_bf16 v[96:111], v[40:43], v[32:35], v[96:111]
    ds_read_b64_tr_b16 v[72:73], v224 offset:13312
    ds_read_b64_tr_b16 v[74:75], v224 offset:13824
    v_mfma_f32_32x32x16_bf16 v[112:127], v[32:35], v[44:47], v[112:127]
    ds_read_b64_tr_b16 v[76:77], v224 offset:14336
    ds_read_b64_tr_b16 v[78:79], v224 offset:14848
    buffer_load_dwordx4 a[4:7], v23, s[64:67], s4 offen offset:0 sc1
    s_waitcnt lgkmcnt(7)
    v_mfma_f32_32x32x16_bf16 v[80:95], v[52:55], v[48:51], v[80:95]
    ds_read_b128 v[32:35], v27 offset:0
    ds_read_b64_tr_b16 v[36:37], v224 offset:18432
    ds_read_b64_tr_b16 v[38:39], v224 offset:18944
    buffer_load_dwordx4 a[8:11], v22, s[64:67], s4 offen offset:2048 sc1
    v_mfma_f32_32x32x16_bf16 v[96:111], v[56:59], v[48:51], v[96:111]
    ds_read_b64_tr_b16 v[40:41], v224 offset:19456
    ds_read_b64_tr_b16 v[42:43], v224 offset:19968
    v_mfma_f32_32x32x16_bf16 v[112:127], v[48:51], v[60:63], v[112:127]
    ds_read_b64_tr_b16 v[44:45], v224 offset:20480
    ds_read_b64_tr_b16 v[46:47], v224 offset:20992
    buffer_load_dwordx4 a[12:15], v23, s[64:67], s4 offen offset:2048 sc1
    s_waitcnt lgkmcnt(7)
    v_mfma_f32_32x32x16_bf16 v[80:95], v[68:71], v[64:67], v[80:95]
    v_mfma_f32_32x32x16_bf16 v[96:111], v[72:75], v[64:67], v[96:111]
    s_waitcnt vmcnt(8) lgkmcnt(0)
    s_barrier
    ds_read_b128 v[48:51], v24 offset:32768
    ds_read_b64_tr_b16 v[52:53], v224 offset:32768
    ds_read_b64_tr_b16 v[54:55], v224 offset:33280
    ds_read_b64_tr_b16 v[56:57], v224 offset:33792
    s_and_b32 s4, s68, 15
    s_lshr_b64 s[68:69], s[68:69], 4
    s_add_u32 m0, s75, 69632
    s_mul_i32 s4, s4, 114688
    s_add_u32 s4, s4, s58
    buffer_load_dwordx4 v14, s[20:23], s4 offen offset:0 lds
    v_mfma_f32_32x32x16_bf16 v[112:127], v[64:67], v[76:79], v[112:127]
    ds_read_b64_tr_b16 v[58:59], v224 offset:34304
    ds_read_b64_tr_b16 v[60:61], v224 offset:34816
    ds_read_b64_tr_b16 v[62:63], v224 offset:35328
    buffer_load_dwordx4 v15, s[20:23], s4 offen offset:1024 lds
    v_mfma_f32_32x32x16_bf16 v[80:95], v[36:39], v[32:35], v[80:95]
    ds_read_b128 v[64:67], v25 offset:32768
    ds_read_b64_tr_b16 v[68:69], v224 offset:38912
    ds_read_b64_tr_b16 v[70:71], v224 offset:39424
    buffer_load_dwordx4 v16, s[20:23], s4 offen offset:2048 lds
    v_mfma_f32_32x32x16_bf16 v[96:111], v[40:43], v[32:35], v[96:111]
    ds_read_b64_tr_b16 v[72:73], v224 offset:39936
    ds_read_b64_tr_b16 v[74:75], v224 offset:40448
    v_bfe_u32 v6, v1, 3, 2
    v_lshlrev_b32 v6, 7, v6
    v_and_b32 v7, 7, v1
    v_lshl_add_u32 v6, v7, 2, v6
    s_lshl_b32 s3, s25, 1
    s_lshr_b32 s7, s24, 1
    s_add_u32 s3, s3, s7
    s_lshl_b32 s3, s3, 9
    s_add_u32 s3, s3, 786432
    buffer_load_dword v208, v6, s[16:19], s3 offen sc1
    s_lshl_b32 s3, s31, 10
    s_add_u32 s3, s3, 786432
    s_and_b32 s6, s24, 1
    s_lshl_b32 s7, s6, 9
    v_add_u32 v6, s7, v6
    v_xor_b32 v7, 0x200, v6
    buffer_load_dword v210, v6, s[16:19], s3 offen sc1
    buffer_load_dword v211, v7, s[16:19], s3 offen sc1
    s_lshl_b32 s3, s31, 7
    s_lshl_b32 s7, s6, 6
    s_add_u32 s3, s3, s7
    v_and_b32 v6, 31, v1
    v_lshl_add_u32 v6, v6, 1, s3
    global_load_ushort v209, v6, s[52:53]
    s_min_u32 s3, s28, 27
    s_lshl_b32 s3, s3, 7
    s_lshr_b32 s7, s24, 1
    s_lshl_b32 s7, s7, 6
    s_add_u32 s3, s3, s7
    v_lshl_add_u32 v6, v9, 3, s3
    global_load_dwordx2 v[200:201], v6, s[48:49] offset:0
    global_load_dwordx2 v[202:203], v6, s[48:49] offset:16
    global_load_dwordx2 v[204:205], v6, s[48:49] offset:32
    global_load_dwordx2 v[206:207], v6, s[48:49] offset:48
    v_mfma_f32_32x32x16_bf16 v[112:127], v[32:35], v[44:47], v[112:127]
    ds_read_b64_tr_b16 v[76:77], v224 offset:40960
    ds_read_b64_tr_b16 v[78:79], v224 offset:41472
    buffer_load_dwordx4 v17, s[20:23], s4 offen offset:3072 lds
    s_waitcnt lgkmcnt(7)
    v_mfma_f32_32x32x16_bf16 v[80:95], v[52:55], v[48:51], v[80:95]
    ds_read_b128 v[32:35], v26 offset:32768
    ds_read_b64_tr_b16 v[36:37], v224 offset:45056
    ds_read_b64_tr_b16 v[38:39], v224 offset:45568
    s_and_b32 s4, s44, 15
    s_lshr_b64 s[44:45], s[44:45], 4
    s_lshl_b32 s4, s4, 12
    s_add_u32 s4, s4, s59
    buffer_load_dwordx4 a[16:19], v22, s[64:67], s4 offen offset:0 sc1
    v_mfma_f32_32x32x16_bf16 v[96:111], v[56:59], v[48:51], v[96:111]
    ds_read_b64_tr_b16 v[40:41], v224 offset:46080
    ds_read_b64_tr_b16 v[42:43], v224 offset:46592
    v_mfma_f32_32x32x16_bf16 v[112:127], v[48:51], v[60:63], v[112:127]
    ds_read_b64_tr_b16 v[44:45], v224 offset:47104
    ds_read_b64_tr_b16 v[46:47], v224 offset:47616
    buffer_load_dwordx4 a[20:23], v23, s[64:67], s4 offen offset:0 sc1
    s_waitcnt lgkmcnt(7)
    v_mfma_f32_32x32x16_bf16 v[80:95], v[68:71], v[64:67], v[80:95]
    ds_read_b128 v[48:51], v27 offset:32768
    ds_read_b64_tr_b16 v[52:53], v224 offset:51200
    ds_read_b64_tr_b16 v[54:55], v224 offset:51712
    buffer_load_dwordx4 a[24:27], v22, s[64:67], s4 offen offset:2048 sc1
    v_mfma_f32_32x32x16_bf16 v[96:111], v[72:75], v[64:67], v[96:111]
    ds_read_b64_tr_b16 v[56:57], v224 offset:52224
    ds_read_b64_tr_b16 v[58:59], v224 offset:52736
    v_mfma_f32_32x32x16_bf16 v[112:127], v[64:67], v[76:79], v[112:127]
    ds_read_b64_tr_b16 v[60:61], v224 offset:53248
    ds_read_b64_tr_b16 v[62:63], v224 offset:53760
    buffer_load_dwordx4 a[28:31], v23, s[64:67], s4 offen offset:2048 sc1
    s_waitcnt lgkmcnt(7)
    v_mfma_f32_32x32x16_bf16 v[80:95], v[36:39], v[32:35], v[80:95]
    v_mfma_f32_32x32x16_bf16 v[96:111], v[40:43], v[32:35], v[96:111]
    s_waitcnt lgkmcnt(0)
    s_barrier
    s_and_b32 s4, s68, 15
    s_lshr_b64 s[68:69], s[68:69], 4
    s_add_u32 m0, s75, 0
    s_mul_i32 s4, s4, 114688
    s_add_u32 s4, s4, s58
    buffer_load_dwordx4 v14, s[20:23], s4 offen offset:0 lds
    v_mfma_f32_32x32x16_bf16 v[112:127], v[32:35], v[44:47], v[112:127]
    buffer_load_dwordx4 v15, s[20:23], s4 offen offset:1024 lds
    v_mfma_f32_32x32x16_bf16 v[80:95], v[52:55], v[48:51], v[80:95]
    buffer_load_dwordx4 v16, s[20:23], s4 offen offset:2048 lds
    v_mfma_f32_32x32x16_bf16 v[96:111], v[56:59], v[48:51], v[96:111]
    v_mfma_f32_32x32x16_bf16 v[112:127], v[48:51], v[60:63], v[112:127]
    buffer_load_dwordx4 v17, s[20:23], s4 offen offset:3072 lds
    s_nop 9
    v_cvt_pk_bf16_f32 v128, v96, v97
    s_and_b32 s4, s44, 15
    s_lshr_b64 s[44:45], s[44:45], 4
    s_lshl_b32 s4, s4, 12
    s_add_u32 s4, s4, s59
    buffer_load_dwordx4 a[32:35], v22, s[64:67], s4 offen offset:0 sc1
    v_cvt_pk_bf16_f32 v129, v98, v99
    v_cvt_pk_bf16_f32 v130, v100, v101
    v_cvt_pk_bf16_f32 v131, v102, v103
    v_cvt_pk_bf16_f32 v132, v104, v105
    v_cvt_pk_bf16_f32 v133, v106, v107
    v_cvt_pk_bf16_f32 v134, v108, v109
    v_cvt_pk_bf16_f32 v135, v110, v111
    v_mfma_f32_32x32x16_bf16 v[136:151], v[248:251], v[128:131], 0
    buffer_load_dwordx4 a[36:39], v23, s[64:67], s4 offen offset:0 sc1
    v_mfma_f32_32x32x16_bf16 v[136:151], v[252:255], v[132:135], v[136:151]
    v_cvt_pk_bf16_f32 v32, v112, v113
    buffer_load_dwordx4 a[40:43], v22, s[64:67], s4 offen offset:2048 sc1
    v_cvt_pk_bf16_f32 v33, v114, v115
    v_cvt_pk_bf16_f32 v34, v116, v117
    v_cvt_pk_bf16_f32 v35, v118, v119
    v_cvt_pk_bf16_f32 v36, v120, v121
    v_cvt_pk_bf16_f32 v37, v122, v123
    v_cvt_pk_bf16_f32 v38, v124, v125
    v_cvt_pk_bf16_f32 v39, v126, v127
    v_cndmask_b32 v40, 0, v32, s[36:37]
    v_cndmask_b32 v48, v32, 0, s[36:37]
    buffer_load_dwordx4 a[44:47], v23, s[64:67], s4 offen offset:2048 sc1
    v_cndmask_b32 v41, 0, v33, s[36:37]
    v_cndmask_b32 v49, v33, 0, s[36:37]
    v_cndmask_b32 v42, 0, v34, s[36:37]
    v_cndmask_b32 v50, v34, 0, s[36:37]
    v_cndmask_b32 v43, 0, v35, s[36:37]
    v_cndmask_b32 v51, v35, 0, s[36:37]
    v_cndmask_b32 v44, 0, v36, s[36:37]
    v_cndmask_b32 v52, v36, 0, s[36:37]
    v_cndmask_b32 v45, 0, v37, s[36:37]
    s_and_b32 s4, s68, 15
    s_lshr_b64 s[68:69], s[68:69], 4
    s_add_u32 m0, s75, 4096
    s_mul_i32 s4, s4, 114688
    s_add_u32 s4, s4, s58
    buffer_load_dwordx4 v14, s[20:23], s4 offen offset:0 lds
    v_cndmask_b32 v53, v37, 0, s[36:37]
    v_cndmask_b32 v46, 0, v38, s[36:37]
    v_cndmask_b32 v54, v38, 0, s[36:37]
    v_cndmask_b32 v47, 0, v39, s[36:37]
    v_cndmask_b32 v55, v39, 0, s[36:37]
    v_max3_f32 v184, v136, v137, v138
    v_max3_f32 v185, v144, v145, v146
    v_min3_f32 v186, v136, v137, v138
    v_min3_f32 v187, v144, v145, v146
    buffer_load_dwordx4 v15, s[20:23], s4 offen offset:1024 lds
    v_max3_f32 v184, v184, v139, v140
    v_max3_f32 v185, v185, v147, v148
    v_min3_f32 v186, v186, v139, v140
    v_min3_f32 v187, v187, v147, v148
    v_max3_f32 v184, v184, v141, v142
    v_max3_f32 v185, v185, v149, v150
    v_min3_f32 v186, v186, v141, v142
    v_min3_f32 v187, v187, v149, v150
    v_max_f32 v184, v184, v143
    buffer_load_dwordx4 v16, s[20:23], s4 offen offset:2048 lds
    v_max_f32 v185, v185, v151
    v_min_f32 v186, v186, v143
    v_min_f32 v187, v187, v151
    v_permlane32_swap_b32 v184, v185
    s_nop 0
    v_permlane32_swap_b32 v186, v187
    v_max_f32 v184, v184, v185
    v_min_f32 v186, v186, v187
    v_mul_f32 v184, s74, v184
    v_mul_f32 v186, s74, v186
    buffer_load_dwordx4 v17, s[20:23], s4 offen offset:3072 lds
    v_mov_b32 v185, v184
    v_mov_b32 v187, v186
    s_nop 0
    v_permlane32_swap_b32 v184, v185
    v_permlane32_swap_b32 v186, v187
    v_pk_fma_f32 v[152:153], v[136:137], s[74:75], v[184:185] op_sel:[0,0,0] op_sel_hi:[1,0,0] neg_lo:[0,0,1] neg_hi:[0,0,1]
    v_pk_fma_f32 v[160:161], v[136:137], s[74:75], v[186:187] op_sel:[0,0,0] op_sel_hi:[1,0,0] neg_lo:[1,0,0] neg_hi:[1,0,0]
    v_pk_fma_f32 v[154:155], v[138:139], s[74:75], v[184:185] op_sel:[0,0,0] op_sel_hi:[1,0,0] neg_lo:[0,0,1] neg_hi:[0,0,1]
    v_pk_fma_f32 v[162:163], v[138:139], s[74:75], v[186:187] op_sel:[0,0,0] op_sel_hi:[1,0,0] neg_lo:[1,0,0] neg_hi:[1,0,0]
    v_pk_fma_f32 v[156:157], v[140:141], s[74:75], v[184:185] op_sel:[0,0,0] op_sel_hi:[1,0,0] neg_lo:[0,0,1] neg_hi:[0,0,1]
    s_and_b32 s4, s44, 15
    s_lshr_b64 s[44:45], s[44:45], 4
    s_lshl_b32 s4, s4, 12
    s_add_u32 s4, s4, s59
    buffer_load_dwordx4 a[48:51], v22, s[64:67], s4 offen offset:0 sc1
    v_pk_fma_f32 v[164:165], v[140:141], s[74:75], v[186:187] op_sel:[0,0,0] op_sel_hi:[1,0,0] neg_lo:[1,0,0] neg_hi:[1,0,0]
    v_pk_fma_f32 v[158:159], v[142:143], s[74:75], v[184:185] op_sel:[0,0,0] op_sel_hi:[1,0,0] neg_lo:[0,0,1] neg_hi:[0,0,1]
    v_pk_fma_f32 v[166:167], v[142:143], s[74:75], v[186:187] op_sel:[0,0,0] op_sel_hi:[1,0,0] neg_lo:[1,0,0] neg_hi:[1,0,0]
    v_exp_f32 v152, v152
    v_exp_f32 v153, v153
    v_exp_f32 v154, v154
    buffer_load_dwordx4 a[52:55], v23, s[64:67], s4 offen offset:0 sc1
    v_exp_f32 v155, v155
    v_exp_f32 v156, v156
    v_exp_f32 v157, v157
    v_exp_f32 v158, v158
    v_exp_f32 v159, v159
    buffer_load_dwordx4 a[56:59], v22, s[64:67], s4 offen offset:2048 sc1
    v_exp_f32 v160, v160
    v_exp_f32 v161, v161
    v_exp_f32 v162, v162
    v_exp_f32 v163, v163
    v_exp_f32 v164, v164
    buffer_load_dwordx4 a[60:63], v23, s[64:67], s4 offen offset:2048 sc1
    v_exp_f32 v165, v165
    v_exp_f32 v166, v166
    v_exp_f32 v167, v167
    v_pk_fma_f32 v[168:169], v[144:145], s[74:75], v[184:185] op_sel:[0,0,1] op_sel_hi:[1,0,1] neg_lo:[0,0,1] neg_hi:[0,0,1]
    v_pk_fma_f32 v[176:177], v[144:145], s[74:75], v[186:187] op_sel:[0,0,1] op_sel_hi:[1,0,1] neg_lo:[1,0,0] neg_hi:[1,0,0]
    v_pk_fma_f32 v[170:171], v[146:147], s[74:75], v[184:185] op_sel:[0,0,1] op_sel_hi:[1,0,1] neg_lo:[0,0,1] neg_hi:[0,0,1]
    s_and_b32 s4, s68, 15
    s_lshr_b64 s[68:69], s[68:69], 4
    s_add_u32 m0, s75, 32768
    s_mul_i32 s4, s4, 114688
    s_add_u32 s4, s4, s58
    buffer_load_dwordx4 v14, s[20:23], s4 offen offset:0 lds
    v_pk_fma_f32 v[178:179], v[146:147], s[74:75], v[186:187] op_sel:[0,0,1] op_sel_hi:[1,0,1] neg_lo:[1,0,0] neg_hi:[1,0,0]
    v_pk_fma_f32 v[172:173], v[148:149], s[74:75], v[184:185] op_sel:[0,0,1] op_sel_hi:[1,0,1] neg_lo:[0,0,1] neg_hi:[0,0,1]
    v_pk_fma_f32 v[180:181], v[148:149], s[74:75], v[186:187] op_sel:[0,0,1] op_sel_hi:[1,0,1] neg_lo:[1,0,0] neg_hi:[1,0,0]
    v_pk_fma_f32 v[174:175], v[150:151], s[74:75], v[184:185] op_sel:[0,0,1] op_sel_hi:[1,0,1] neg_lo:[0,0,1] neg_hi:[0,0,1]
    v_pk_fma_f32 v[182:183], v[150:151], s[74:75], v[186:187] op_sel:[0,0,1] op_sel_hi:[1,0,1] neg_lo:[1,0,0] neg_hi:[1,0,0]
    v_exp_f32 v168, v168
    v_exp_f32 v169, v169
    buffer_load_dwordx4 v15, s[20:23], s4 offen offset:1024 lds
    v_exp_f32 v170, v170
    v_exp_f32 v171, v171
    v_exp_f32 v172, v172
    v_exp_f32 v173, v173
    v_exp_f32 v174, v174
    buffer_load_dwordx4 v16, s[20:23], s4 offen offset:2048 lds
    v_exp_f32 v175, v175
    v_exp_f32 v176, v176
    v_exp_f32 v177, v177
    v_exp_f32 v178, v178
    v_exp_f32 v179, v179
    buffer_load_dwordx4 v17, s[20:23], s4 offen offset:3072 lds
    v_exp_f32 v180, v180
    v_exp_f32 v181, v181
    v_exp_f32 v182, v182
    v_exp_f32 v183, v183
    v_pk_add_f32 v[192:193], v[152:153], v[154:155]
    s_and_b32 s4, s44, 15
    s_lshr_b64 s[44:45], s[44:45], 4
    s_lshl_b32 s4, s4, 12
    s_add_u32 s4, s4, s59
    buffer_load_dwordx4 a[64:67], v22, s[64:67], s4 offen offset:0 sc1
    v_pk_add_f32 v[194:195], v[160:161], v[162:163]
    v_pk_add_f32 v[196:197], v[168:169], v[170:171]
    v_pk_add_f32 v[198:199], v[176:177], v[178:179]
    v_pk_add_f32 v[192:193], v[192:193], v[156:157]
    v_pk_add_f32 v[194:195], v[194:195], v[164:165]
    v_pk_add_f32 v[196:197], v[196:197], v[172:173]
    v_pk_add_f32 v[198:199], v[198:199], v[180:181]
    v_pk_add_f32 v[192:193], v[192:193], v[158:159]
    v_pk_add_f32 v[194:195], v[194:195], v[166:167]
    buffer_load_dwordx4 a[68:71], v23, s[64:67], s4 offen offset:0 sc1
    v_pk_add_f32 v[196:197], v[196:197], v[174:175]
    v_pk_add_f32 v[198:199], v[198:199], v[182:183]
    v_add_f32 v188, v192, v193
    v_add_f32 v189, v194, v195
    v_add_f32 v190, v196, v197
    v_add_f32 v191, v198, v199
    v_permlane32_swap_b32 v188, v189
    s_nop 0
    v_permlane32_swap_b32 v190, v191
    v_add_f32 v188, v188, v189
    buffer_load_dwordx4 a[72:75], v22, s[64:67], s4 offen offset:2048 sc1
    v_add_f32 v190, v190, v191
    v_rcp_f32 v188, v188
    v_rcp_f32 v190, v190
    v_mov_b32 v189, v188
    v_mov_b32 v191, v190
    s_nop 0
    v_permlane32_swap_b32 v188, v189
    v_permlane32_swap_b32 v190, v191
    buffer_load_dwordx4 a[76:79], v23, s[64:67], s4 offen offset:2048 sc1
    v_pk_mul_f32 v[152:153], v[152:153], v[188:189] op_sel:[0,0] op_sel_hi:[1,0]
    v_pk_mul_f32 v[154:155], v[154:155], v[188:189] op_sel:[0,0] op_sel_hi:[1,0]
    v_pk_mul_f32 v[156:157], v[156:157], v[188:189] op_sel:[0,0] op_sel_hi:[1,0]
    v_pk_mul_f32 v[158:159], v[158:159], v[188:189] op_sel:[0,0] op_sel_hi:[1,0]
    v_cvt_pk_bf16_f32 v136, v152, v153
    v_cvt_pk_bf16_f32 v137, v154, v155
    v_cvt_pk_bf16_f32 v138, v156, v157
    v_cvt_pk_bf16_f32 v139, v158, v159
    v_pk_mul_f32 v[160:161], v[160:161], v[188:189] op_sel:[0,1] op_sel_hi:[1,1]
    s_and_b32 s4, s44, 15
    s_lshr_b64 s[44:45], s[44:45], 4
    s_lshl_b32 s4, s4, 12
    s_add_u32 s4, s4, s59
    buffer_load_dwordx4 a[80:83], v22, s[64:67], s4 offen offset:0 sc1
    v_pk_mul_f32 v[162:163], v[162:163], v[188:189] op_sel:[0,1] op_sel_hi:[1,1]
    v_pk_mul_f32 v[164:165], v[164:165], v[188:189] op_sel:[0,1] op_sel_hi:[1,1]
    v_pk_mul_f32 v[166:167], v[166:167], v[188:189] op_sel:[0,1] op_sel_hi:[1,1]
    v_cvt_pk_bf16_f32 v140, v160, v161
    v_cvt_pk_bf16_f32 v141, v162, v163
    v_cvt_pk_bf16_f32 v142, v164, v165
    v_cvt_pk_bf16_f32 v143, v166, v167
    v_pk_mul_f32 v[168:169], v[168:169], v[190:191] op_sel:[0,0] op_sel_hi:[1,0]
    v_pk_mul_f32 v[170:171], v[170:171], v[190:191] op_sel:[0,0] op_sel_hi:[1,0]
    buffer_load_dwordx4 a[84:87], v23, s[64:67], s4 offen offset:0 sc1
    v_pk_mul_f32 v[172:173], v[172:173], v[190:191] op_sel:[0,0] op_sel_hi:[1,0]
    v_pk_mul_f32 v[174:175], v[174:175], v[190:191] op_sel:[0,0] op_sel_hi:[1,0]
    v_cvt_pk_bf16_f32 v144, v168, v169
    v_cvt_pk_bf16_f32 v145, v170, v171
    v_cvt_pk_bf16_f32 v146, v172, v173
    v_cvt_pk_bf16_f32 v147, v174, v175
    v_pk_mul_f32 v[176:177], v[176:177], v[190:191] op_sel:[0,1] op_sel_hi:[1,1]
    v_pk_mul_f32 v[178:179], v[178:179], v[190:191] op_sel:[0,1] op_sel_hi:[1,1]
    v_pk_mul_f32 v[180:181], v[180:181], v[190:191] op_sel:[0,1] op_sel_hi:[1,1]
    buffer_load_dwordx4 a[88:91], v22, s[64:67], s4 offen offset:2048 sc1
    v_pk_mul_f32 v[182:183], v[182:183], v[190:191] op_sel:[0,1] op_sel_hi:[1,1]
    v_cvt_pk_bf16_f32 v148, v176, v177
    v_cvt_pk_bf16_f32 v149, v178, v179
    v_cvt_pk_bf16_f32 v150, v180, v181
    v_cvt_pk_bf16_f32 v151, v182, v183
    v_mfma_f32_32x32x16_bf16 v[152:167], v[136:139], v[216:219], 0
    buffer_load_dwordx4 a[92:95], v23, s[64:67], s4 offen offset:2048 sc1
    v_mfma_f32_32x32x16_bf16 v[168:183], v[144:147], v[216:219], 0
    v_mfma_f32_32x32x16_bf16 v[152:167], v[140:143], v[220:223], v[152:167]
    s_and_b32 s4, s44, 15
    s_lshr_b64 s[44:45], s[44:45], 4
    s_lshl_b32 s4, s4, 12
    s_add_u32 s4, s4, s59
    buffer_load_dwordx4 a[96:99], v22, s[64:67], s4 offen offset:0 sc1
    v_mfma_f32_32x32x16_bf16 v[168:183], v[148:151], v[220:223], v[168:183]
    v_cvt_pk_bf16_f32 v240, v80, v81
    buffer_load_dwordx4 a[100:103], v23, s[64:67], s4 offen offset:0 sc1
    v_cvt_pk_bf16_f32 v241, v82, v83
    v_cvt_pk_bf16_f32 v242, v84, v85
    v_cvt_pk_bf16_f32 v243, v86, v87
    v_cvt_pk_bf16_f32 v244, v88, v89
    v_cvt_pk_bf16_f32 v245, v90, v91
    v_cvt_pk_bf16_f32 v246, v92, v93
    v_cvt_pk_bf16_f32 v247, v94, v95
    s_cmp_eq_u32 s5, 0
    s_cselect_b64 s[38:39], -1, 0
    v_cvt_pk_bf16_f32 v64, v152, v153
    v_cvt_pk_bf16_f32 v65, v154, v155
    buffer_load_dwordx4 a[104:107], v22, s[64:67], s4 offen offset:2048 sc1
    v_cvt_pk_bf16_f32 v66, v156, v157
    v_cvt_pk_bf16_f32 v67, v158, v159
    v_cvt_pk_bf16_f32 v68, v160, v161
    v_cvt_pk_bf16_f32 v69, v162, v163
    v_cvt_pk_bf16_f32 v70, v164, v165
    v_cvt_pk_bf16_f32 v71, v166, v167
    v_cvt_pk_bf16_f32 v72, v168, v169
    v_cvt_pk_bf16_f32 v73, v170, v171
    v_cvt_pk_bf16_f32 v74, v172, v173
    buffer_load_dwordx4 a[108:111], v23, s[64:67], s4 offen offset:2048 sc1
    v_cvt_pk_bf16_f32 v75, v174, v175
    v_cvt_pk_bf16_f32 v76, v176, v177
    v_cvt_pk_bf16_f32 v77, v178, v179
    v_cvt_pk_bf16_f32 v78, v180, v181
    v_cvt_pk_bf16_f32 v79, v182, v183
    v_mfma_f32_32x32x16_bf16 v[96:111], v[64:67], v[40:43], 0
    s_and_b32 s4, s44, 15
    s_lshr_b64 s[44:45], s[44:45], 4
    s_lshl_b32 s4, s4, 12
    s_add_u32 s4, s4, s59
    buffer_load_dwordx4 a[112:115], v22, s[64:67], s4 offen offset:0 sc1
    v_mfma_f32_32x32x16_bf16 v[96:111], v[68:71], v[44:47], v[96:111]
    v_mfma_f32_32x32x16_bf16 v[96:111], v[72:75], v[48:51], v[96:111]
    buffer_load_dwordx4 a[116:119], v23, s[64:67], s4 offen offset:0 sc1
    v_mfma_f32_32x32x16_bf16 v[96:111], v[76:79], v[52:55], v[96:111]
    v_pk_add_f32 v[186:187], v[152:153], v[154:155]
    buffer_load_dwordx4 a[120:123], v22, s[64:67], s4 offen offset:2048 sc1
    v_pk_add_f32 v[188:189], v[168:169], v[170:171]
    v_pk_add_f32 v[186:187], v[186:187], v[156:157]
    v_pk_add_f32 v[188:189], v[188:189], v[172:173]
    v_pk_add_f32 v[186:187], v[186:187], v[158:159]
    v_pk_add_f32 v[188:189], v[188:189], v[174:175]
    v_pk_add_f32 v[186:187], v[186:187], v[160:161]
    v_pk_add_f32 v[188:189], v[188:189], v[176:177]
    v_pk_add_f32 v[186:187], v[186:187], v[162:163]
    v_pk_add_f32 v[188:189], v[188:189], v[178:179]
    buffer_load_dwordx4 a[124:127], v23, s[64:67], s4 offen offset:2048 sc1
    v_pk_add_f32 v[186:187], v[186:187], v[164:165]
    v_pk_add_f32 v[188:189], v[188:189], v[180:181]
    v_pk_add_f32 v[186:187], v[186:187], v[166:167]
    v_pk_add_f32 v[188:189], v[188:189], v[182:183]
    v_add_f32 v184, v186, v187
    v_add_f32 v185, v188, v189
    s_nop 1
    v_permlane32_swap_b32 v184, v185
    v_add_f32 v184, v184, v185
    buffer_store_dword v184, v232, s[16:19], s76 offen sc1
    v_cndmask_b32 v136, v96, v104, s[38:39]
    s_and_b32 s4, s44, 15
    s_lshr_b64 s[44:45], s[44:45], 4
    s_lshl_b32 s4, s4, 12
    s_add_u32 s4, s4, s59
    buffer_load_dwordx4 a[128:131], v22, s[64:67], s4 offen offset:0 sc1
    v_cndmask_b32 v137, v97, v105, s[38:39]
    v_cndmask_b32 v138, v98, v106, s[38:39]
    v_cndmask_b32 v139, v99, v107, s[38:39]
    v_cndmask_b32 v140, v100, v108, s[38:39]
    v_cndmask_b32 v141, v101, v109, s[38:39]
    v_cndmask_b32 v142, v102, v110, s[38:39]
    v_cndmask_b32 v143, v103, v111, s[38:39]
    ds_write_b128 v233, v[136:139] offset:36864
    ds_write_b128 v233, v[140:143] offset:37888
    v_cndmask_b32 v128, v104, v96, s[38:39]
    v_cndmask_b32 v129, v105, v97, s[38:39]
    buffer_load_dwordx4 a[132:135], v23, s[64:67], s4 offen offset:0 sc1
    v_cndmask_b32 v130, v106, v98, s[38:39]
    v_cndmask_b32 v131, v107, v99, s[38:39]
    v_cndmask_b32 v132, v108, v100, s[38:39]
    v_cndmask_b32 v133, v109, v101, s[38:39]
    v_cndmask_b32 v134, v110, v102, s[38:39]
    v_cndmask_b32 v135, v111, v103, s[38:39]
    s_mov_b32 s8, s50
    s_mov_b32 s9, s51
    s_mov_b32 s10, 7340032
    s_mov_b32 s11, 0x00020000
    s_mov_b32 s12, s42
    s_mov_b32 s13, s43
    s_mov_b32 s14, 524288
    s_mov_b32 s15, 0x00020000
    s_lshl_b32 s3, s5, 11
    s_add_u32 s76, s76, s3
    s_waitcnt lgkmcnt(0)
    s_barrier
    ds_read_b128 v[136:139], v234 offset:36864
    ds_read_b128 v[140:143], v234 offset:37888
    s_mul_i32 s32, s24, 1835008
    s_lshl_b32 s3, s31, 7
    s_add_u32 s32, s32, s3
    s_lshl_b32 s33, s24, 17
    s_lshl_b32 s3, s27, 7
    s_add_u32 s33, s33, s3
    s_mov_b64 s[78:79], s[70:71]
    s_and_b32 s3, s24, 1
    s_lshl_b32 s3, s3, 6
    v_xor_b32 v7, s3, v8
    v_lshl_add_u32 v7, v9, 9, v7
    v_add_u32 v24, s75, v7
    buffer_load_dwordx4 a[136:139], v22, s[64:67], s4 offen offset:2048 sc1
    v_xor_b32 v25, 64, v24
    v_add_u32 v26, 0x10000, v24
    v_add_u32 v27, 0x10000, v25
    v_add_u32 v28, 0x20000, v24
    v_add_u32 v29, 0x20000, v25
    v_add_u32 v10, 0, v239
    v_add_u32 v11, 7168, v239
    v_add_u32 v12, 14336, v239
    v_add_u32 v13, 21504, v239
    buffer_load_dwordx4 a[140:143], v23, s[64:67], s4 offen offset:2048 sc1
    s_waitcnt lgkmcnt(0)
    v_pk_add_f32 v[128:129], v[128:129], v[136:137]
    v_pk_add_f32 v[130:131], v[130:131], v[138:139]
    v_pk_add_f32 v[132:133], v[132:133], v[140:141]
    v_pk_add_f32 v[134:135], v[134:135], v[142:143]
    buffer_store_dwordx4 v[128:131], v5, s[16:19], s76 offen sc1
    buffer_store_dwordx4 v[132:135], v5, s[16:19], s76 offen offset:1024 sc1
    s_cmp_ge_u32 s29, 28
    s_cbranch_scc1 L_reducer
    ds_read_b64_tr_b16 v[32:33], v228 offset:32768
    s_and_b32 s4, s68, 15
    s_lshr_b64 s[68:69], s[68:69], 4
    s_add_u32 m0, s75, 36864
    s_mul_i32 s4, s4, 114688
    s_add_u32 s4, s4, s58
    buffer_load_dwordx4 v14, s[20:23], s4 offen offset:0 lds
    ds_read_b64_tr_b16 v[34:35], v228 offset:33280
    buffer_load_dwordx4 v15, s[20:23], s4 offen offset:1024 lds
    ds_read_b64_tr_b16 v[36:37], v229 offset:32768
    ds_read_b64_tr_b16 v[38:39], v229 offset:33280
    buffer_load_dwordx4 v16, s[20:23], s4 offen offset:2048 lds
    ds_read_b64_tr_b16 v[40:41], v228 offset:34816
    buffer_load_dwordx4 v17, s[20:23], s4 offen offset:3072 lds
    ds_read_b64_tr_b16 v[42:43], v228 offset:35328
    ds_read_b64_tr_b16 v[44:45], v229 offset:34816
    s_and_b32 s4, s44, 15
    s_lshr_b64 s[44:45], s[44:45], 4
    s_lshl_b32 s4, s4, 12
    s_add_u32 s4, s4, s59
    buffer_load_dwordx4 a[144:147], v22, s[64:67], s4 offen offset:0 sc1
    ds_read_b64_tr_b16 v[46:47], v229 offset:35328
    s_waitcnt vmcnt(63) lgkmcnt(4)
    v_mfma_f32_32x32x16_bf16 v[64:79], v[32:35], a[0:3], 0
    ds_read_b64_tr_b16 v[48:49], v228 offset:36864
    buffer_load_dwordx4 a[148:151], v23, s[64:67], s4 offen offset:0 sc1
    v_mfma_f32_32x32x16_bf16 v[80:95], v[32:35], a[4:7], 0
    ds_read_b64_tr_b16 v[50:51], v228 offset:37376
    v_mfma_f32_32x32x16_bf16 v[96:111], v[36:39], a[0:3], 0
    ds_read_b64_tr_b16 v[52:53], v229 offset:36864
    buffer_load_dwordx4 a[152:155], v22, s[64:67], s4 offen offset:2048 sc1
    v_mfma_f32_32x32x16_bf16 v[112:127], v[36:39], a[4:7], 0
    ds_read_b64_tr_b16 v[54:55], v229 offset:37376
    s_waitcnt lgkmcnt(4)
    v_mfma_f32_32x32x16_bf16 v[64:79], v[40:43], a[8:11], v[64:79]
    ds_read_b64_tr_b16 v[56:57], v228 offset:38912
    buffer_load_dwordx4 a[156:159], v23, s[64:67], s4 offen offset:2048 sc1
    v_mfma_f32_32x32x16_bf16 v[80:95], v[40:43], a[12:15], v[80:95]
    ds_read_b64_tr_b16 v[58:59], v228 offset:39424
    v_mfma_f32_32x32x16_bf16 v[96:111], v[44:47], a[8:11], v[96:111]
    ds_read_b64_tr_b16 v[60:61], v229 offset:38912
    s_and_b32 s4, s68, 15
    s_lshr_b64 s[68:69], s[68:69], 4
    s_add_u32 m0, s75, 98304
    s_mul_i32 s4, s4, 114688
    s_add_u32 s4, s4, s58
    buffer_load_dwordx4 v14, s[20:23], s4 offen offset:0 lds
    v_mfma_f32_32x32x16_bf16 v[112:127], v[44:47], a[12:15], v[112:127]
    ds_read_b64_tr_b16 v[62:63], v229 offset:39424
    s_waitcnt vmcnt(52) lgkmcnt(4)
    v_mfma_f32_32x32x16_bf16 v[64:79], v[48:51], a[16:19], v[64:79]
    ds_read_b64_tr_b16 v[152:153], v230 offset:0
    buffer_load_dwordx4 v15, s[20:23], s4 offen offset:1024 lds
    v_mfma_f32_32x32x16_bf16 v[80:95], v[48:51], a[20:23], v[80:95]
    ds_read_b64_tr_b16 v[154:155], v230 offset:512
    buffer_load_dwordx4 v16, s[20:23], s4 offen offset:2048 lds
    v_mfma_f32_32x32x16_bf16 v[96:111], v[52:55], a[16:19], v[96:111]
    ds_read_b64_tr_b16 v[156:157], v231 offset:0
    v_mfma_f32_32x32x16_bf16 v[112:127], v[52:55], a[20:23], v[112:127]
    ds_read_b64_tr_b16 v[158:159], v231 offset:512
    buffer_load_dwordx4 v17, s[20:23], s4 offen offset:3072 lds
    s_waitcnt vmcnt(12)
    v_mov_b32 v2, s62
    v_mov_b32 v3, s63
    v_mov_b32 v4, 0
    s_mov_b64 exec, 1
    buffer_store_dwordx2 v[2:3], v4, s[16:19], s77 offen sc1
    s_mov_b64 exec, -1
    s_waitcnt lgkmcnt(4)
    s_nop 2
    v_mfma_f32_32x32x16_bf16 v[64:79], v[56:59], a[24:27], v[64:79]
    ds_read_b64_tr_b16 v[160:161], v230 offset:2048
    s_and_b32 s4, s44, 15
    s_lshr_b64 s[44:45], s[44:45], 4
    s_lshl_b32 s4, s4, 12
    s_add_u32 s4, s4, s59
    buffer_load_dwordx4 a[160:163], v22, s[64:67], s4 offen offset:0 sc1
    v_mfma_f32_32x32x16_bf16 v[80:95], v[56:59], a[28:31], v[80:95]
    ds_read_b64_tr_b16 v[162:163], v230 offset:2560
    v_mfma_f32_32x32x16_bf16 v[96:111], v[60:63], a[24:27], v[96:111]
    ds_read_b64_tr_b16 v[164:165], v231 offset:2048
    buffer_load_dwordx4 a[164:167], v23, s[64:67], s4 offen offset:0 sc1
    v_mfma_f32_32x32x16_bf16 v[112:127], v[60:63], a[28:31], v[112:127]
    ds_read_b64_tr_b16 v[166:167], v231 offset:2560
    s_waitcnt lgkmcnt(4)
    v_mfma_f32_32x32x16_bf16 v[64:79], v[152:155], a[32:35], v[64:79]
    ds_read_b64_tr_b16 v[32:33], v230 offset:4096
    buffer_load_dwordx4 a[168:171], v22, s[64:67], s4 offen offset:2048 sc1
    v_mfma_f32_32x32x16_bf16 v[80:95], v[152:155], a[36:39], v[80:95]
    ds_read_b64_tr_b16 v[34:35], v230 offset:4608
    v_mfma_f32_32x32x16_bf16 v[96:111], v[156:159], a[32:35], v[96:111]
    ds_read_b64_tr_b16 v[36:37], v231 offset:4096
    buffer_load_dwordx4 a[172:175], v23, s[64:67], s4 offen offset:2048 sc1
    v_mfma_f32_32x32x16_bf16 v[112:127], v[156:159], a[36:39], v[112:127]
    ds_read_b64_tr_b16 v[38:39], v231 offset:4608
    s_waitcnt lgkmcnt(4)
    v_mfma_f32_32x32x16_bf16 v[64:79], v[160:163], a[40:43], v[64:79]
    ds_read_b64_tr_b16 v[40:41], v230 offset:6144
    s_and_b32 s4, s68, 15
    s_lshr_b64 s[68:69], s[68:69], 4
    s_add_u32 m0, s75, 102400
    s_mul_i32 s4, s4, 114688
    s_add_u32 s4, s4, s58
    buffer_load_dwordx4 v14, s[20:23], s4 offen offset:0 lds
    v_mfma_f32_32x32x16_bf16 v[80:95], v[160:163], a[44:47], v[80:95]
    ds_read_b64_tr_b16 v[42:43], v230 offset:6656
    v_mfma_f32_32x32x16_bf16 v[96:111], v[164:167], a[40:43], v[96:111]
    ds_read_b64_tr_b16 v[44:45], v231 offset:6144
    buffer_load_dwordx4 v15, s[20:23], s4 offen offset:1024 lds
    v_mfma_f32_32x32x16_bf16 v[112:127], v[164:167], a[44:47], v[112:127]
    ds_read_b64_tr_b16 v[46:47], v231 offset:6656
    s_waitcnt lgkmcnt(4)
    v_mfma_f32_32x32x16_bf16 v[64:79], v[32:35], a[48:51], v[64:79]
    ds_read_b64_tr_b16 v[48:49], v228 offset:0
    buffer_load_dwordx4 v16, s[20:23], s4 offen offset:2048 lds
    v_mfma_f32_32x32x16_bf16 v[80:95], v[32:35], a[52:55], v[80:95]
    ds_read_b64_tr_b16 v[50:51], v228 offset:512
    buffer_load_dwordx4 v17, s[20:23], s4 offen offset:3072 lds
    v_mfma_f32_32x32x16_bf16 v[96:111], v[36:39], a[48:51], v[96:111]
    ds_read_b64_tr_b16 v[52:53], v229 offset:0
    v_mfma_f32_32x32x16_bf16 v[112:127], v[36:39], a[52:55], v[112:127]
    ds_read_b64_tr_b16 v[54:55], v229 offset:512
    s_and_b32 s4, s44, 15
    s_lshr_b64 s[44:45], s[44:45], 4
    s_lshl_b32 s4, s4, 12
    s_add_u32 s4, s4, s59
    buffer_load_dwordx4 a[176:179], v22, s[64:67], s4 offen offset:0 sc1
    s_waitcnt lgkmcnt(4)
    v_mfma_f32_32x32x16_bf16 v[64:79], v[40:43], a[56:59], v[64:79]
    ds_read_b64_tr_b16 v[56:57], v228 offset:2048
    buffer_load_dwordx4 a[180:183], v23, s[64:67], s4 offen offset:0 sc1
    v_mfma_f32_32x32x16_bf16 v[80:95], v[40:43], a[60:63], v[80:95]
    ds_read_b64_tr_b16 v[58:59], v228 offset:2560
    v_mfma_f32_32x32x16_bf16 v[96:111], v[44:47], a[56:59], v[96:111]
    ds_read_b64_tr_b16 v[60:61], v229 offset:2048
    buffer_load_dwordx4 a[184:187], v22, s[64:67], s4 offen offset:2048 sc1
    v_mfma_f32_32x32x16_bf16 v[112:127], v[44:47], a[60:63], v[112:127]
    ds_read_b64_tr_b16 v[62:63], v229 offset:2560
    s_waitcnt lgkmcnt(4)
    v_mfma_f32_32x32x16_bf16 v[64:79], v[48:51], a[64:67], v[64:79]
    ds_read_b64_tr_b16 v[152:153], v228 offset:4096
    buffer_load_dwordx4 a[188:191], v23, s[64:67], s4 offen offset:2048 sc1
    v_mfma_f32_32x32x16_bf16 v[80:95], v[48:51], a[68:71], v[80:95]
    ds_read_b64_tr_b16 v[154:155], v228 offset:4608
    v_mfma_f32_32x32x16_bf16 v[96:111], v[52:55], a[64:67], v[96:111]
    ds_read_b64_tr_b16 v[156:157], v229 offset:4096
    s_and_b32 s4, s68, 15
    s_lshr_b64 s[68:69], s[68:69], 4
    s_add_u32 m0, s75, 131072
    s_mul_i32 s4, s4, 114688
    s_add_u32 s4, s4, s58
    buffer_load_dwordx4 v14, s[20:23], s4 offen offset:0 lds
    v_mfma_f32_32x32x16_bf16 v[112:127], v[52:55], a[68:71], v[112:127]
    ds_read_b64_tr_b16 v[158:159], v229 offset:4608
    s_waitcnt lgkmcnt(4)
    v_mfma_f32_32x32x16_bf16 v[64:79], v[56:59], a[72:75], v[64:79]
    ds_read_b64_tr_b16 v[160:161], v228 offset:6144
    buffer_load_dwordx4 v15, s[20:23], s4 offen offset:1024 lds
    v_mfma_f32_32x32x16_bf16 v[80:95], v[56:59], a[76:79], v[80:95]
    ds_read_b64_tr_b16 v[162:163], v228 offset:6656
    v_mfma_f32_32x32x16_bf16 v[96:111], v[60:63], a[72:75], v[96:111]
    ds_read_b64_tr_b16 v[164:165], v229 offset:6144
    buffer_load_dwordx4 v16, s[20:23], s4 offen offset:2048 lds
    v_mfma_f32_32x32x16_bf16 v[112:127], v[60:63], a[76:79], v[112:127]
    ds_read_b64_tr_b16 v[166:167], v229 offset:6656
    s_waitcnt lgkmcnt(4)
    v_mfma_f32_32x32x16_bf16 v[64:79], v[152:155], a[80:83], v[64:79]
    ds_read_b64_tr_b16 v[32:33], v226 offset:0
    buffer_load_dwordx4 v17, s[20:23], s4 offen offset:3072 lds
    v_mfma_f32_32x32x16_bf16 v[80:95], v[152:155], a[84:87], v[80:95]
    ds_read_b64_tr_b16 v[34:35], v226 offset:512
    s_and_b32 s4, s44, 15
    s_lshr_b64 s[44:45], s[44:45], 4
    s_lshl_b32 s4, s4, 12
    s_add_u32 s4, s4, s59
    buffer_load_dwordx4 a[192:195], v22, s[64:67], s4 offen offset:0 sc1
    v_mfma_f32_32x32x16_bf16 v[96:111], v[156:159], a[80:83], v[96:111]
    ds_read_b64_tr_b16 v[36:37], v227 offset:0
    v_mfma_f32_32x32x16_bf16 v[112:127], v[156:159], a[84:87], v[112:127]
    ds_read_b64_tr_b16 v[38:39], v227 offset:512
    buffer_load_dwordx4 a[196:199], v23, s[64:67], s4 offen offset:0 sc1
    s_waitcnt lgkmcnt(4)
    v_mfma_f32_32x32x16_bf16 v[64:79], v[160:163], a[88:91], v[64:79]
    ds_read_b64_tr_b16 v[40:41], v226 offset:2048
    buffer_load_dwordx4 a[200:203], v22, s[64:67], s4 offen offset:2048 sc1
    v_mfma_f32_32x32x16_bf16 v[80:95], v[160:163], a[92:95], v[80:95]
    ds_read_b64_tr_b16 v[42:43], v226 offset:2560
    v_mfma_f32_32x32x16_bf16 v[96:111], v[164:167], a[88:91], v[96:111]
    ds_read_b64_tr_b16 v[44:45], v227 offset:2048
    buffer_load_dwordx4 a[204:207], v23, s[64:67], s4 offen offset:2048 sc1
    v_mfma_f32_32x32x16_bf16 v[112:127], v[164:167], a[92:95], v[112:127]
    ds_read_b64_tr_b16 v[46:47], v227 offset:2560
    s_waitcnt lgkmcnt(4)
    v_mfma_f32_32x32x16_bf16 v[64:79], v[32:35], a[96:99], v[64:79]
    ds_read_b64_tr_b16 v[48:49], v226 offset:4096
    s_and_b32 s4, s68, 15
    s_lshr_b64 s[68:69], s[68:69], 4
    s_add_u32 m0, s75, 135168
    s_mul_i32 s4, s4, 114688
    s_add_u32 s4, s4, s58
    buffer_load_dwordx4 v14, s[20:23], s4 offen offset:0 lds
    v_mfma_f32_32x32x16_bf16 v[80:95], v[32:35], a[100:103], v[80:95]
    ds_read_b64_tr_b16 v[50:51], v226 offset:4608
    v_mfma_f32_32x32x16_bf16 v[96:111], v[36:39], a[96:99], v[96:111]
    ds_read_b64_tr_b16 v[52:53], v227 offset:4096
    buffer_load_dwordx4 v15, s[20:23], s4 offen offset:1024 lds
    v_mfma_f32_32x32x16_bf16 v[112:127], v[36:39], a[100:103], v[112:127]
    ds_read_b64_tr_b16 v[54:55], v227 offset:4608
    s_waitcnt lgkmcnt(4)
    v_mfma_f32_32x32x16_bf16 v[64:79], v[40:43], a[104:107], v[64:79]
    ds_read_b64_tr_b16 v[56:57], v226 offset:6144
    buffer_load_dwordx4 v16, s[20:23], s4 offen offset:2048 lds
    v_mfma_f32_32x32x16_bf16 v[80:95], v[40:43], a[108:111], v[80:95]
    ds_read_b64_tr_b16 v[58:59], v226 offset:6656
    v_mfma_f32_32x32x16_bf16 v[96:111], v[44:47], a[104:107], v[96:111]
    ds_read_b64_tr_b16 v[60:61], v227 offset:6144
    buffer_load_dwordx4 v17, s[20:23], s4 offen offset:3072 lds
    v_mfma_f32_32x32x16_bf16 v[112:127], v[44:47], a[108:111], v[112:127]
    ds_read_b64_tr_b16 v[62:63], v227 offset:6656
    s_waitcnt lgkmcnt(4)
    v_mfma_f32_32x32x16_bf16 v[64:79], v[48:51], a[112:115], v[64:79]
    ds_read_b64_tr_b16 v[152:153], v226 offset:32768
    s_and_b32 s4, s44, 15
    s_lshr_b64 s[44:45], s[44:45], 4
    s_lshl_b32 s4, s4, 12
    s_add_u32 s4, s4, s59
    buffer_load_dwordx4 a[208:211], v22, s[64:67], s4 offen offset:0 sc1
    v_mfma_f32_32x32x16_bf16 v[80:95], v[48:51], a[116:119], v[80:95]
    ds_read_b64_tr_b16 v[154:155], v226 offset:33280
    buffer_load_dwordx4 a[212:215], v23, s[64:67], s4 offen offset:0 sc1
    v_mfma_f32_32x32x16_bf16 v[96:111], v[52:55], a[112:115], v[96:111]
    ds_read_b64_tr_b16 v[156:157], v227 offset:32768
    v_mfma_f32_32x32x16_bf16 v[112:127], v[52:55], a[116:119], v[112:127]
    ds_read_b64_tr_b16 v[158:159], v227 offset:33280
    buffer_load_dwordx4 a[216:219], v22, s[64:67], s4 offen offset:2048 sc1
    v_lshlrev_b32 v128, 16, v200
    v_and_b32 v129, 0xffff0000, v200
    v_lshlrev_b32 v130, 16, v201
    v_and_b32 v131, 0xffff0000, v201
    v_lshlrev_b32 v132, 16, v202
    v_and_b32 v133, 0xffff0000, v202
    v_lshlrev_b32 v134, 16, v203
    v_and_b32 v135, 0xffff0000, v203
    v_lshlrev_b32 v136, 16, v204
    v_and_b32 v137, 0xffff0000, v204
    v_lshlrev_b32 v138, 16, v205
    v_and_b32 v139, 0xffff0000, v205
    v_lshlrev_b32 v140, 16, v206
    v_and_b32 v141, 0xffff0000, v206
    v_lshlrev_b32 v142, 16, v207
    v_and_b32 v143, 0xffff0000, v207
    s_waitcnt lgkmcnt(4)
    v_mfma_f32_32x32x16_bf16 v[64:79], v[56:59], a[120:123], v[64:79]
    ds_read_b64_tr_b16 v[160:161], v226 offset:34816
    buffer_load_dwordx4 a[220:223], v23, s[64:67], s4 offen offset:2048 sc1
    v_mfma_f32_32x32x16_bf16 v[80:95], v[56:59], a[124:127], v[80:95]
    ds_read_b64_tr_b16 v[162:163], v226 offset:35328
    v_mfma_f32_32x32x16_bf16 v[96:111], v[60:63], a[120:123], v[96:111]
    ds_read_b64_tr_b16 v[164:165], v227 offset:34816
    s_and_b32 s4, s68, 15
    s_lshr_b64 s[68:69], s[68:69], 4
    s_add_u32 m0, s75, 65536
    s_mul_i32 s4, s4, 114688
    s_add_u32 s4, s4, s58
    buffer_load_dwordx4 v14, s[20:23], s4 offen offset:0 lds
    v_mfma_f32_32x32x16_bf16 v[112:127], v[60:63], a[124:127], v[112:127]
    ds_read_b64_tr_b16 v[166:167], v227 offset:35328
    s_waitcnt lgkmcnt(4)
    v_mfma_f32_32x32x16_bf16 v[64:79], v[152:155], a[128:131], v[64:79]
    s_waitcnt vmcnt(38)
    ds_read_b64_tr_b16 v[32:33], v226 offset:36864
    buffer_load_dwordx4 v15, s[20:23], s4 offen offset:1024 lds
    v_mfma_f32_32x32x16_bf16 v[80:95], v[152:155], a[132:135], v[80:95]
    ds_read_b64_tr_b16 v[34:35], v226 offset:37376
    v_mfma_f32_32x32x16_bf16 v[96:111], v[156:159], a[128:131], v[96:111]
    ds_read_b64_tr_b16 v[36:37], v227 offset:36864
    buffer_load_dwordx4 v16, s[20:23], s4 offen offset:2048 lds
    v_mfma_f32_32x32x16_bf16 v[112:127], v[156:159], a[132:135], v[112:127]
    ds_read_b64_tr_b16 v[38:39], v227 offset:37376
    s_mul_i32 s3, s27, 229376
    s_lshl_b32 s7, s28, 13
    s_add_u32 s3, s3, s7
    s_lshr_b32 s7, s24, 1
    s_lshl_b32 s7, s7, 12
    s_add_u32 s3, s3, s7
    s_and_b32 s7, s24, 1
    s_lshl_b32 s7, s7, 10
    s_add_u32 s3, s3, s7
    s_add_u32 s76, s3, 8396800
    s_mul_i32 s3, s27, 28
    s_add_u32 s3, s3, s28
    s_lshl_b32 s3, s3, 7
    s_add_u32 s77, s3, 524288
    s_waitcnt lgkmcnt(4)
    v_mfma_f32_32x32x16_bf16 v[64:79], v[160:163], a[136:139], v[64:79]
    ds_read_b64_tr_b16 v[40:41], v226 offset:38912
    buffer_load_dwordx4 v17, s[20:23], s4 offen offset:3072 lds
    v_mfma_f32_32x32x16_bf16 v[80:95], v[160:163], a[140:143], v[80:95]
    ds_read_b64_tr_b16 v[42:43], v226 offset:39424
    v_mfma_f32_32x32x16_bf16 v[96:111], v[164:167], a[136:139], v[96:111]
    ds_read_b64_tr_b16 v[44:45], v227 offset:38912
    s_and_b32 s4, s44, 15
    s_lshr_b64 s[44:45], s[44:45], 4
    s_lshl_b32 s4, s4, 12
    s_add_u32 s4, s4, s59
    buffer_load_dwordx4 a[224:227], v22, s[64:67], s4 offen offset:0 sc1
    v_mfma_f32_32x32x16_bf16 v[112:127], v[164:167], a[140:143], v[112:127]
    ds_read_b64_tr_b16 v[46:47], v227 offset:39424
    s_waitcnt vmcnt(38) lgkmcnt(4)
    v_mfma_f32_32x32x16_bf16 v[64:79], v[32:35], a[144:147], v[64:79]
    s_waitcnt vmcnt(34)
    ds_read_b64_tr_b16 v[48:49], v228 offset:32768
    buffer_load_dwordx4 a[228:231], v23, s[64:67], s4 offen offset:0 sc1
    v_mfma_f32_32x32x16_bf16 v[80:95], v[32:35], a[148:151], v[80:95]
    ds_read_b64_tr_b16 v[50:51], v228 offset:33280
    buffer_load_dwordx4 a[232:235], v22, s[64:67], s4 offen offset:2048 sc1
    v_mfma_f32_32x32x16_bf16 v[96:111], v[36:39], a[144:147], v[96:111]
    ds_read_b64_tr_b16 v[52:53], v229 offset:32768
    v_mfma_f32_32x32x16_bf16 v[112:127], v[36:39], a[148:151], v[112:127]
    ds_read_b64_tr_b16 v[54:55], v229 offset:33280
    buffer_load_dwordx4 a[236:239], v23, s[64:67], s4 offen offset:2048 sc1
    s_xor_b32 s3, s24, 1
    s_lshl_b32 s3, s3, 13
    v_add_u32 v234, s3, v5
    s_xor_b32 s3, s24, 2
    s_lshl_b32 s3, s3, 13
    v_add_u32 v235, s3, v5
    s_xor_b32 s3, s24, 3
    s_lshl_b32 s3, s3, 13
    v_add_u32 v239, s3, v5
    v_add_u32 v233, s75, v5
    s_waitcnt lgkmcnt(4)
    v_mfma_f32_32x32x16_bf16 v[64:79], v[40:43], a[152:155], v[64:79]
    ds_read_b64_tr_b16 v[56:57], v228 offset:34816
    s_and_b32 s4, s68, 15
    s_lshr_b64 s[68:69], s[68:69], 4
    s_add_u32 m0, s75, 69632
    s_mul_i32 s4, s4, 114688
    s_add_u32 s4, s4, s58
    buffer_load_dwordx4 v14, s[20:23], s4 offen offset:0 lds
    v_mfma_f32_32x32x16_bf16 v[80:95], v[40:43], a[156:159], v[80:95]
    ds_read_b64_tr_b16 v[58:59], v228 offset:35328
    v_mfma_f32_32x32x16_bf16 v[96:111], v[44:47], a[152:155], v[96:111]
    ds_read_b64_tr_b16 v[60:61], v229 offset:34816
    buffer_load_dwordx4 v15, s[20:23], s4 offen offset:1024 lds
    v_mfma_f32_32x32x16_bf16 v[112:127], v[44:47], a[156:159], v[112:127]
    ds_read_b64_tr_b16 v[62:63], v229 offset:35328
    s_waitcnt vmcnt(34) lgkmcnt(4)
    v_mfma_f32_32x32x16_bf16 v[64:79], v[48:51], a[160:163], v[64:79]
    s_waitcnt vmcnt(30)
    ds_read_b64_tr_b16 v[152:153], v228 offset:36864
    buffer_load_dwordx4 v16, s[20:23], s4 offen offset:2048 lds
    v_mfma_f32_32x32x16_bf16 v[80:95], v[48:51], a[164:167], v[80:95]
    ds_read_b64_tr_b16 v[154:155], v228 offset:37376
    v_mfma_f32_32x32x16_bf16 v[96:111], v[52:55], a[160:163], v[96:111]
    ds_read_b64_tr_b16 v[156:157], v229 offset:36864
    buffer_load_dwordx4 v17, s[20:23], s4 offen offset:3072 lds
    v_mfma_f32_32x32x16_bf16 v[112:127], v[52:55], a[164:167], v[112:127]
    ds_read_b64_tr_b16 v[158:159], v229 offset:37376
    s_barrier
    s_waitcnt lgkmcnt(4)
    v_mfma_f32_32x32x16_bf16 v[64:79], v[56:59], a[168:171], v[64:79]
    ds_read_b64_tr_b16 v[160:161], v228 offset:38912
    s_and_b32 s4, s44, 15
    s_lshr_b64 s[44:45], s[44:45], 4
    s_lshl_b32 s4, s4, 12
    s_add_u32 s4, s4, s59
    buffer_load_dwordx4 a[240:243], v22, s[64:67], s4 offen offset:0 sc1
    v_mfma_f32_32x32x16_bf16 v[80:95], v[56:59], a[172:175], v[80:95]
    ds_read_b64_tr_b16 v[162:163], v228 offset:39424
    v_mfma_f32_32x32x16_bf16 v[96:111], v[60:63], a[168:171], v[96:111]
    ds_read_b64_tr_b16 v[164:165], v229 offset:38912
    buffer_load_dwordx4 a[244:247], v23, s[64:67], s4 offen offset:0 sc1
    v_mfma_f32_32x32x16_bf16 v[112:127], v[60:63], a[172:175], v[112:127]
    ds_read_b64_tr_b16 v[166:167], v229 offset:39424
    s_waitcnt vmcnt(30) lgkmcnt(4)
    v_mfma_f32_32x32x16_bf16 v[64:79], v[152:155], a[176:179], v[64:79]
    s_waitcnt vmcnt(26)
    ds_read_b64_tr_b16 v[32:33], v230 offset:0
    ds_read_b64_tr_b16 v[34:35], v230 offset:512
    buffer_load_dwordx4 a[248:251], v22, s[64:67], s4 offen offset:2048 sc1
    v_mfma_f32_32x32x16_bf16 v[80:95], v[152:155], a[180:183], v[80:95]
    ds_read_b64_tr_b16 v[36:37], v231 offset:0
    ds_read_b64_tr_b16 v[38:39], v231 offset:512
    buffer_load_dwordx4 a[252:255], v23, s[64:67], s4 offen offset:2048 sc1
    v_mfma_f32_32x32x16_bf16 v[96:111], v[156:159], a[176:179], v[96:111]
    ds_read_b64_tr_b16 v[40:41], v230 offset:2048
    ds_read_b64_tr_b16 v[42:43], v230 offset:2560
    v_mfma_f32_32x32x16_bf16 v[112:127], v[156:159], a[180:183], v[112:127]
    ds_read_b64_tr_b16 v[44:45], v231 offset:2048
    ds_read_b64_tr_b16 v[46:47], v231 offset:2560
    s_waitcnt lgkmcnt(8)
    v_mfma_f32_32x32x16_bf16 v[64:79], v[160:163], a[184:187], v[64:79]
    s_waitcnt vmcnt(20)
    ds_read_b64_tr_b16 v[48:49], v230 offset:4096
    ds_read_b64_tr_b16 v[50:51], v230 offset:4608
    s_and_b32 s4, s70, 15
    s_lshr_b64 s[70:71], s[70:71], 4
    s_add_u32 m0, s75, 36864
    s_lshl_b32 s4, s4, 17
    s_add_u32 s4, s4, s32
    buffer_load_dwordx4 v18, s[8:11], s4 offen offset:0 lds
    v_mfma_f32_32x32x16_bf16 v[80:95], v[160:163], a[188:191], v[80:95]
    ds_read_b64_tr_b16 v[52:53], v231 offset:4096
    ds_read_b64_tr_b16 v[54:55], v231 offset:4608
    v_mfma_f32_32x32x16_bf16 v[96:111], v[164:167], a[184:187], v[96:111]
    ds_read_b64_tr_b16 v[56:57], v230 offset:6144
    ds_read_b64_tr_b16 v[58:59], v230 offset:6656
    buffer_load_dwordx4 v19, s[8:11], s4 offen offset:1024 lds
    v_mfma_f32_32x32x16_bf16 v[112:127], v[164:167], a[188:191], v[112:127]
    ds_read_b64_tr_b16 v[60:61], v231 offset:6144
    ds_read_b64_tr_b16 v[62:63], v231 offset:6656
    s_waitcnt lgkmcnt(12)
    v_mfma_f32_32x32x16_bf16 v[64:79], v[32:35], a[192:195], v[64:79]
    s_waitcnt vmcnt(14)
    ds_read_b64_tr_b16 v[152:153], v228 offset:0
    ds_read_b64_tr_b16 v[154:155], v228 offset:512
    buffer_load_dwordx4 v20, s[8:11], s4 offen offset:2048 lds
    v_mfma_f32_32x32x16_bf16 v[80:95], v[32:35], a[196:199], v[80:95]
    ds_read_b64_tr_b16 v[156:157], v229 offset:0
    ds_read_b64_tr_b16 v[158:159], v229 offset:512
    v_mfma_f32_32x32x16_bf16 v[96:111], v[36:39], a[192:195], v[96:111]
    ds_read_b64_tr_b16 v[160:161], v228 offset:2048
    ds_read_b64_tr_b16 v[162:163], v228 offset:2560
    buffer_load_dwordx4 v21, s[8:11], s4 offen offset:3072 lds
    v_mfma_f32_32x32x16_bf16 v[112:127], v[36:39], a[196:199], v[112:127]
    ds_read_b64_tr_b16 v[164:165], v229 offset:2048
    ds_read_b64_tr_b16 v[166:167], v229 offset:2560
    s_waitcnt lgkmcnt(15)
    v_mfma_f32_32x32x16_bf16 v[64:79], v[40:43], a[200:203], v[64:79]
    s_waitcnt vmcnt(8)
    ds_read_b64_tr_b16 v[32:33], v228 offset:4096
    s_and_b32 s4, s70, 15
    s_lshr_b64 s[70:71], s[70:71], 4
    s_add_u32 m0, s75, 98304
    s_lshl_b32 s4, s4, 17
    s_add_u32 s4, s4, s32
    buffer_load_dwordx4 v18, s[8:11], s4 offen offset:0 lds
    v_mfma_f32_32x32x16_bf16 v[80:95], v[40:43], a[204:207], v[80:95]
    ds_read_b64_tr_b16 v[34:35], v228 offset:4608
    v_mfma_f32_32x32x16_bf16 v[96:111], v[44:47], a[200:203], v[96:111]
    ds_read_b64_tr_b16 v[36:37], v229 offset:4096
    buffer_load_dwordx4 v19, s[8:11], s4 offen offset:1024 lds
    v_mfma_f32_32x32x16_bf16 v[112:127], v[44:47], a[204:207], v[112:127]
    ds_read_b64_tr_b16 v[38:39], v229 offset:4608
    ds_read_b64_tr_b16 v[40:41], v228 offset:6144
    ds_read_b64_tr_b16 v[42:43], v228 offset:6656
    ds_read_b64_tr_b16 v[44:45], v229 offset:6144
    ds_read_b64_tr_b16 v[46:47], v229 offset:6656
    s_waitcnt lgkmcnt(15)
    v_mfma_f32_32x32x16_bf16 v[80:95], v[48:51], a[212:215], v[80:95]
    buffer_load_dwordx4 v20, s[8:11], s4 offen offset:2048 lds
    v_mfma_f32_32x32x16_bf16 v[80:95], v[56:59], a[220:223], v[80:95]
    s_waitcnt lgkmcnt(12)
    v_mfma_f32_32x32x16_bf16 v[80:95], v[152:155], a[228:231], v[80:95]
    buffer_load_dwordx4 v21, s[8:11], s4 offen offset:3072 lds
    s_waitcnt lgkmcnt(8)
    v_mfma_f32_32x32x16_bf16 v[80:95], v[160:163], a[236:239], v[80:95]
    s_waitcnt vmcnt(8) lgkmcnt(4)
    v_mfma_f32_32x32x16_bf16 v[80:95], v[32:35], a[244:247], v[80:95]
    s_waitcnt lgkmcnt(0)
    v_mfma_f32_32x32x16_bf16 v[80:95], v[40:43], a[252:255], v[80:95]
    v_mfma_f32_32x32x16_bf16 v[96:111], v[52:55], a[208:211], v[96:111]
    v_mfma_f32_32x32x16_bf16 v[96:111], v[60:63], a[216:219], v[96:111]
    v_mfma_f32_32x32x16_bf16 v[96:111], v[156:159], a[224:227], v[96:111]
    s_nop 8
    ds_write_b128 v234, v[80:83] offset:0
    v_mfma_f32_32x32x16_bf16 v[96:111], v[164:167], a[232:235], v[96:111]
    ds_write_b128 v234, v[84:87] offset:1024
    v_mfma_f32_32x32x16_bf16 v[96:111], v[36:39], a[240:243], v[96:111]
    ds_write_b128 v234, v[88:91] offset:2048
    v_mfma_f32_32x32x16_bf16 v[96:111], v[44:47], a[248:251], v[96:111]
    ds_write_b128 v234, v[92:95] offset:3072
    v_mfma_f32_32x32x16_bf16 v[112:127], v[52:55], a[212:215], v[112:127]
    v_mfma_f32_32x32x16_bf16 v[112:127], v[60:63], a[220:223], v[112:127]
    v_mfma_f32_32x32x16_bf16 v[112:127], v[156:159], a[228:231], v[112:127]
    s_nop 7
    ds_write_b128 v235, v[96:99] offset:4096
    v_mfma_f32_32x32x16_bf16 v[112:127], v[164:167], a[236:239], v[112:127]
    ds_write_b128 v235, v[100:103] offset:5120
    v_mfma_f32_32x32x16_bf16 v[112:127], v[36:39], a[244:247], v[112:127]
    ds_write_b128 v235, v[104:107] offset:6144
    v_mfma_f32_32x32x16_bf16 v[112:127], v[44:47], a[252:255], v[112:127]
    ds_write_b128 v235, v[108:111] offset:7168
    v_mfma_f32_32x32x16_bf16 v[64:79], v[48:51], a[208:211], v[64:79]
    v_mfma_f32_32x32x16_bf16 v[64:79], v[56:59], a[216:219], v[64:79]
    v_mfma_f32_32x32x16_bf16 v[64:79], v[152:155], a[224:227], v[64:79]
    s_nop 7
    ds_write_b128 v239, v[112:115] offset:32768
    v_mfma_f32_32x32x16_bf16 v[64:79], v[160:163], a[232:235], v[64:79]
    ds_write_b128 v239, v[116:119] offset:33792
    v_mfma_f32_32x32x16_bf16 v[64:79], v[32:35], a[240:243], v[64:79]
    ds_write_b128 v239, v[120:123] offset:34816
    v_mfma_f32_32x32x16_bf16 v[64:79], v[40:43], a[248:251], v[64:79]
    ds_write_b128 v239, v[124:127] offset:35840
    s_waitcnt lgkmcnt(0)
    s_barrier
    ds_read_b128 v[80:83], v233 offset:0
    ds_read_b128 v[84:87], v233 offset:1024
    ds_read_b128 v[88:91], v233 offset:2048
    ds_read_b128 v[92:95], v233 offset:3072
    ds_read_b128 v[96:99], v233 offset:4096
    ds_read_b128 v[100:103], v233 offset:5120
    ds_read_b128 v[104:107], v233 offset:6144
    ds_read_b128 v[108:111], v233 offset:7168
    ds_read_b128 v[112:115], v233 offset:32768
    ds_read_b128 v[116:119], v233 offset:33792
    ds_read_b128 v[120:123], v233 offset:34816
    ds_read_b128 v[124:127], v233 offset:35840
    v_pk_add_f32 v[64:65], v[64:65], v[128:129]
    v_pk_add_f32 v[66:67], v[66:67], v[130:131]
    v_pk_add_f32 v[68:69], v[68:69], v[132:133]
    v_pk_add_f32 v[70:71], v[70:71], v[134:135]
    v_pk_add_f32 v[72:73], v[72:73], v[136:137]
    v_pk_add_f32 v[74:75], v[74:75], v[138:139]
    v_pk_add_f32 v[76:77], v[76:77], v[140:141]
    v_pk_add_f32 v[78:79], v[78:79], v[142:143]
    s_waitcnt lgkmcnt(8)
    v_pk_add_f32 v[64:65], v[64:65], v[80:81]
    s_and_b32 s4, s73, 15
    s_lshr_b32 s73, s73, 4
    s_add_u32 m0, s75, 102400
    s_lshl_b32 s4, s4, 15
    s_add_u32 s4, s4, s33
    buffer_load_dwordx4 v10, s[12:15], s4 offen offset:0 lds
    v_pk_add_f32 v[66:67], v[66:67], v[82:83]
    v_pk_add_f32 v[68:69], v[68:69], v[84:85]
    v_pk_add_f32 v[70:71], v[70:71], v[86:87]
    v_pk_add_f32 v[72:73], v[72:73], v[88:89]
    v_pk_add_f32 v[74:75], v[74:75], v[90:91]
    v_pk_add_f32 v[76:77], v[76:77], v[92:93]
    v_pk_add_f32 v[78:79], v[78:79], v[94:95]
    s_waitcnt lgkmcnt(4)
    v_pk_add_f32 v[64:65], v[64:65], v[96:97]
    v_pk_add_f32 v[66:67], v[66:67], v[98:99]
    buffer_load_dwordx4 v11, s[12:15], s4 offen offset:1024 lds
    v_pk_add_f32 v[68:69], v[68:69], v[100:101]
    v_pk_add_f32 v[70:71], v[70:71], v[102:103]
    v_pk_add_f32 v[72:73], v[72:73], v[104:105]
    v_pk_add_f32 v[74:75], v[74:75], v[106:107]
    v_pk_add_f32 v[76:77], v[76:77], v[108:109]
    v_pk_add_f32 v[78:79], v[78:79], v[110:111]
    s_waitcnt lgkmcnt(0)
    v_pk_add_f32 v[64:65], v[64:65], v[112:113]
    v_pk_add_f32 v[66:67], v[66:67], v[114:115]
    v_pk_add_f32 v[68:69], v[68:69], v[116:117]
    buffer_load_dwordx4 v12, s[12:15], s4 offen offset:2048 lds
    v_pk_add_f32 v[70:71], v[70:71], v[118:119]
    v_pk_add_f32 v[72:73], v[72:73], v[120:121]
    v_pk_add_f32 v[74:75], v[74:75], v[122:123]
    v_pk_add_f32 v[76:77], v[76:77], v[124:125]
    v_pk_add_f32 v[78:79], v[78:79], v[126:127]
    s_mov_b32 s6, 0xbdd2d3e8
    v_mov_b32 v2, 0xc0135761
    v_pk_mul_f32 v[144:145], v[64:65], v[64:65]
    v_pk_mul_f32 v[146:147], v[66:67], v[66:67]
    v_pk_mul_f32 v[148:149], v[68:69], v[68:69]
    buffer_load_dwordx4 v13, s[12:15], s4 offen offset:3072 lds
    v_pk_mul_f32 v[150:151], v[70:71], v[70:71]
    v_pk_mul_f32 v[152:153], v[72:73], v[72:73]
    v_pk_mul_f32 v[154:155], v[74:75], v[74:75]
    v_pk_mul_f32 v[156:157], v[76:77], v[76:77]
    v_pk_mul_f32 v[158:159], v[78:79], v[78:79]
    v_pk_fma_f32 v[144:145], v[144:145], s[6:7], v[2:3] op_sel_hi:[1,0,0]
    v_pk_fma_f32 v[146:147], v[146:147], s[6:7], v[2:3] op_sel_hi:[1,0,0]
    v_pk_fma_f32 v[148:149], v[148:149], s[6:7], v[2:3] op_sel_hi:[1,0,0]
    v_pk_fma_f32 v[150:151], v[150:151], s[6:7], v[2:3] op_sel_hi:[1,0,0]
    s_and_b32 s4, s70, 15
    s_lshr_b64 s[70:71], s[70:71], 4
    s_add_u32 m0, s75, 131072
    s_lshl_b32 s4, s4, 17
    s_add_u32 s4, s4, s32
    buffer_load_dwordx4 v18, s[8:11], s4 offen offset:0 lds
    v_pk_fma_f32 v[152:153], v[152:153], s[6:7], v[2:3] op_sel_hi:[1,0,0]
    v_pk_fma_f32 v[154:155], v[154:155], s[6:7], v[2:3] op_sel_hi:[1,0,0]
    v_pk_fma_f32 v[156:157], v[156:157], s[6:7], v[2:3] op_sel_hi:[1,0,0]
    v_pk_fma_f32 v[158:159], v[158:159], s[6:7], v[2:3] op_sel_hi:[1,0,0]
    v_pk_mul_f32 v[144:145], v[144:145], v[64:65]
    v_pk_mul_f32 v[146:147], v[146:147], v[66:67]
    v_pk_mul_f32 v[148:149], v[148:149], v[68:69]
    v_pk_mul_f32 v[150:151], v[150:151], v[70:71]
    v_pk_mul_f32 v[152:153], v[152:153], v[72:73]
    buffer_load_dwordx4 v19, s[8:11], s4 offen offset:1024 lds
    v_pk_mul_f32 v[154:155], v[154:155], v[74:75]
    v_pk_mul_f32 v[156:157], v[156:157], v[76:77]
    v_pk_mul_f32 v[158:159], v[158:159], v[78:79]
    v_exp_f32 v144, v144
    v_exp_f32 v145, v145
    v_exp_f32 v146, v146
    buffer_load_dwordx4 v20, s[8:11], s4 offen offset:2048 lds
    v_exp_f32 v147, v147
    v_exp_f32 v148, v148
    v_exp_f32 v149, v149
    v_exp_f32 v150, v150
    v_exp_f32 v151, v151
    buffer_load_dwordx4 v21, s[8:11], s4 offen offset:3072 lds
    v_exp_f32 v152, v152
    v_exp_f32 v153, v153
    v_exp_f32 v154, v154
    v_exp_f32 v155, v155
    v_exp_f32 v156, v156
    v_exp_f32 v157, v157
    v_exp_f32 v158, v158
    v_exp_f32 v159, v159
    v_pk_add_f32 v[144:145], v[144:145], 1.0 op_sel_hi:[1,0]
    v_pk_add_f32 v[146:147], v[146:147], 1.0 op_sel_hi:[1,0]
    v_pk_add_f32 v[148:149], v[148:149], 1.0 op_sel_hi:[1,0]
    v_pk_add_f32 v[150:151], v[150:151], 1.0 op_sel_hi:[1,0]
    v_pk_add_f32 v[152:153], v[152:153], 1.0 op_sel_hi:[1,0]
    v_pk_add_f32 v[154:155], v[154:155], 1.0 op_sel_hi:[1,0]
    v_pk_add_f32 v[156:157], v[156:157], 1.0 op_sel_hi:[1,0]
    v_pk_add_f32 v[158:159], v[158:159], 1.0 op_sel_hi:[1,0]
    v_rcp_f32 v144, v144
    v_rcp_f32 v145, v145
    v_rcp_f32 v146, v146
    v_rcp_f32 v147, v147
    v_rcp_f32 v148, v148
    v_rcp_f32 v149, v149
    v_rcp_f32 v150, v150
    v_rcp_f32 v151, v151
    v_rcp_f32 v152, v152
    v_rcp_f32 v153, v153
    v_rcp_f32 v154, v154
    v_rcp_f32 v155, v155
    v_rcp_f32 v156, v156
    v_rcp_f32 v157, v157
    v_rcp_f32 v158, v158
    v_rcp_f32 v159, v159
    v_pk_mul_f32 v[64:65], v[64:65], v[144:145]
    v_pk_mul_f32 v[66:67], v[66:67], v[146:147]
    v_pk_mul_f32 v[68:69], v[68:69], v[148:149]
    v_pk_mul_f32 v[70:71], v[70:71], v[150:151]
    v_pk_mul_f32 v[72:73], v[72:73], v[152:153]
    v_pk_mul_f32 v[74:75], v[74:75], v[154:155]
    v_pk_mul_f32 v[76:77], v[76:77], v[156:157]
    v_pk_mul_f32 v[78:79], v[78:79], v[158:159]
    v_cvt_pk_bf16_f32 v128, v64, v65
    v_cvt_pk_bf16_f32 v129, v66, v67
    v_cvt_pk_bf16_f32 v130, v68, v69
    v_cvt_pk_bf16_f32 v131, v70, v71
    v_cvt_pk_bf16_f32 v132, v72, v73
    v_cvt_pk_bf16_f32 v133, v74, v75
    v_cvt_pk_bf16_f32 v134, v76, v77
    v_cvt_pk_bf16_f32 v135, v78, v79
    buffer_store_dwordx4 v[128:131], v5, s[16:19], s76 offen sc1
    buffer_store_dwordx4 v[132:135], v5, s[16:19], s76 offen offset:2048 sc1
    s_lshl_b32 s3, s2, 2
    s_add_u32 s3, s3, s24
    s_cmp_lg_u32 s3, 0
    s_cbranch_scc1 L_noE_5
    s_mov_b32 s3, 0
    v_mov_b32 v2, s62
    v_mov_b32 v3, s63
    v_mov_b32 v4, 0
    s_mov_b64 exec, 1
    buffer_store_dwordx2 v[2:3], v4, s[16:19], s3 offen sc1
    s_mov_b64 exec, -1
L_noE_5:
    s_branch L_join
L_reducer:
    s_lshl_b32 s34, s30, 2
    s_add_u32 s34, s34, s29
    s_sub_u32 s34, s34, 28
    s_lshr_b32 s3, s34, 1
    s_lshl_b32 s4, s3, 13
    s_lshl_b32 s5, s24, 11
    s_add_u32 s4, s4, s5
    s_add_u32 s4, s4, 393216
    v_and_b32 v6, 15, v1
    v_lshl_add_u32 v238, v6, 7, s4
    s_and_b32 s5, s34, 1
    v_and_b32 v6, 15, v1
    v_lshl_add_u32 v6, v9, 5, v6
    v_lshlrev_b32 v6, 4, v6
    s_lshl_b32 s4, s5, 8
    v_add_u32 v6, s4, v6
    v_bfe_u32 v7, v1, 3, 1
    v_lshlrev_b32 v7, 8, v7
    v_lshl_add_u32 v7, v9, 4, v7
    s_lshl_b32 s4, s5, 7
    s_add_u32 s4, s4, 4096
    v_add_u32 v7, s4, v7
    v_add_u32 v2, 0, v6
    v_add_u32 v3, 0, v7
    v_cndmask_b32 v60, v3, v2, s[36:37]
    v_add_u32 v2, 1024, v6
    v_add_u32 v3, 32, v7
    v_cndmask_b32 v61, v3, v2, s[36:37]
    v_add_u32 v2, 2048, v6
    v_add_u32 v3, 64, v7
    v_cndmask_b32 v62, v3, v2, s[36:37]
    v_add_u32 v2, 3072, v6
    v_add_u32 v3, 96, v7
    v_cndmask_b32 v63, v3, v2, s[36:37]
    s_lshl_b32 s3, s3, 5
    s_lshl_b32 s4, s24, 3
    s_add_u32 s3, s3, s4
    s_mul_i32 s3, s3, 4608
    s_add_u32 s76, s3, 3149824
    s_xor_b32 s3, s24, 1
    s_lshl_b32 s3, s3, 13
    v_add_u32 v234, s3, v5
    s_xor_b32 s3, s24, 2
    s_lshl_b32 s3, s3, 13
    v_add_u32 v235, s3, v5
    s_xor_b32 s3, s24, 3
    s_lshl_b32 s3, s3, 13
    v_add_u32 v239, s3, v5
    v_add_u32 v233, s75, v5
    s_waitcnt vmcnt(0)
    v_mov_b32 v2, s62
    v_mov_b32 v3, s63
    v_mov_b32 v4, 0
    s_mov_b64 exec, 1
    buffer_store_dwordx2 v[2:3], v4, s[16:19], s77 offen sc1
    s_mov_b64 exec, -1
    s_and_b32 s4, s70, 15
    s_lshr_b64 s[70:71], s[70:71], 4
    s_add_u32 m0, s75, 36864
    s_lshl_b32 s4, s4, 17
    s_add_u32 s4, s4, s32
    buffer_load_dwordx4 v18, s[8:11], s4 offen offset:0 lds
    buffer_load_dwordx4 v19, s[8:11], s4 offen offset:1024 lds
    buffer_load_dwordx4 v20, s[8:11], s4 offen offset:2048 lds
    buffer_load_dwordx4 v21, s[8:11], s4 offen offset:3072 lds
    s_and_b32 s4, s70, 15
    s_lshr_b64 s[70:71], s[70:71], 4
    s_add_u32 m0, s75, 98304
    s_lshl_b32 s4, s4, 17
    s_add_u32 s4, s4, s32
    buffer_load_dwordx4 v18, s[8:11], s4 offen offset:0 lds
    buffer_load_dwordx4 v19, s[8:11], s4 offen offset:1024 lds
    buffer_load_dwordx4 v20, s[8:11], s4 offen offset:2048 lds
    buffer_load_dwordx4 v21, s[8:11], s4 offen offset:3072 lds
    s_and_b32 s4, s73, 15
    s_lshr_b32 s73, s73, 4
    s_add_u32 m0, s75, 102400
    s_lshl_b32 s4, s4, 15
    s_add_u32 s4, s4, s33
    buffer_load_dwordx4 v10, s[12:15], s4 offen offset:0 lds
    buffer_load_dwordx4 v11, s[12:15], s4 offen offset:1024 lds
    buffer_load_dwordx4 v12, s[12:15], s4 offen offset:2048 lds
    buffer_load_dwordx4 v13, s[12:15], s4 offen offset:3072 lds
    s_and_b32 s4, s70, 15
    s_lshr_b64 s[70:71], s[70:71], 4
    s_add_u32 m0, s75, 131072
    s_lshl_b32 s4, s4, 17
    s_add_u32 s4, s4, s32
    buffer_load_dwordx4 v18, s[8:11], s4 offen offset:0 lds
    buffer_load_dwordx4 v19, s[8:11], s4 offen offset:1024 lds
    buffer_load_dwordx4 v20, s[8:11], s4 offen offset:2048 lds
    buffer_load_dwordx4 v21, s[8:11], s4 offen offset:3072 lds
    s_mov_b32 s5, 50000
    s_mov_b64 vcc, -1
L_rp_6:
    s_and_b32 s3, vcc_lo, 3
    s_cbranch_scc0 L_rok_7
    buffer_load_dwordx2 v[236:237], v238, s[16:19], 0 offen sc1
    s_waitcnt vmcnt(0)
    v_cmp_ne_u64 vcc, s[62:63], v[236:237]
    s_sub_u32 s5, s5, 1
    s_cmp_gt_i32 s5, 0
    s_nop 2
    s_cbranch_scc1 L_rp_6
L_rok_7:
    buffer_load_dwordx4 v[64:67], v60, s[16:19], s76 offen sc1
    buffer_load_dwordx4 v[68:71], v61, s[16:19], s76 offen sc1
    buffer_load_dwordx4 v[72:75], v62, s[16:19], s76 offen sc1
    buffer_load_dwordx4 v[76:79], v63, s[16:19], s76 offen sc1
    s_add_u32 s76, s76, 4608
L_rp_8:
    s_and_b32 s3, vcc_lo, 12
    s_cbranch_scc0 L_rok_9
    buffer_load_dwordx2 v[236:237], v238, s[16:19], 0 offen sc1
    s_waitcnt vmcnt(0)
    v_cmp_ne_u64 vcc, s[62:63], v[236:237]
    s_sub_u32 s5, s5, 1
    s_cmp_gt_i32 s5, 0
    s_nop 2
    s_cbranch_scc1 L_rp_8
L_rok_9:
    buffer_load_dwordx4 v[80:83], v60, s[16:19], s76 offen sc1
    buffer_load_dwordx4 v[84:87], v61, s[16:19], s76 offen sc1
    buffer_load_dwordx4 v[88:91], v62, s[16:19], s76 offen sc1
    buffer_load_dwordx4 v[92:95], v63, s[16:19], s76 offen sc1
    s_add_u32 s76, s76, 4608
L_rp_10:
    s_and_b32 s3, vcc_lo, 48
    s_cbranch_scc0 L_rok_11
    buffer_load_dwordx2 v[236:237], v238, s[16:19], 0 offen sc1
    s_waitcnt vmcnt(0)
    v_cmp_ne_u64 vcc, s[62:63], v[236:237]
    s_sub_u32 s5, s5, 1
    s_cmp_gt_i32 s5, 0
    s_nop 2
    s_cbranch_scc1 L_rp_10
L_rok_11:
    buffer_load_dwordx4 v[96:99], v60, s[16:19], s76 offen sc1
    buffer_load_dwordx4 v[100:103], v61, s[16:19], s76 offen sc1
    buffer_load_dwordx4 v[104:107], v62, s[16:19], s76 offen sc1
    buffer_load_dwordx4 v[108:111], v63, s[16:19], s76 offen sc1
    s_add_u32 s76, s76, 4608
L_rp_12:
    s_and_b32 s3, vcc_lo, 192
    s_cbranch_scc0 L_rok_13
    buffer_load_dwordx2 v[236:237], v238, s[16:19], 0 offen sc1
    s_waitcnt vmcnt(0)
    v_cmp_ne_u64 vcc, s[62:63], v[236:237]
    s_sub_u32 s5, s5, 1
    s_cmp_gt_i32 s5, 0
    s_nop 2
    s_cbranch_scc1 L_rp_12
L_rok_13:
    buffer_load_dwordx4 v[112:115], v60, s[16:19], s76 offen sc1
    buffer_load_dwordx4 v[116:119], v61, s[16:19], s76 offen sc1
    buffer_load_dwordx4 v[120:123], v62, s[16:19], s76 offen sc1
    buffer_load_dwordx4 v[124:127], v63, s[16:19], s76 offen sc1
    s_add_u32 s76, s76, 4608
L_rp_14:
    s_and_b32 s3, vcc_lo, 768
    s_cbranch_scc0 L_rok_15
    buffer_load_dwordx2 v[236:237], v238, s[16:19], 0 offen sc1
    s_waitcnt vmcnt(0)
    v_cmp_ne_u64 vcc, s[62:63], v[236:237]
    s_sub_u32 s5, s5, 1
    s_cmp_gt_i32 s5, 0
    s_nop 2
    s_cbranch_scc1 L_rp_14
L_rok_15:
    buffer_load_dwordx4 v[128:131], v60, s[16:19], s76 offen sc1
    buffer_load_dwordx4 v[132:135], v61, s[16:19], s76 offen sc1
    buffer_load_dwordx4 v[136:139], v62, s[16:19], s76 offen sc1
    buffer_load_dwordx4 v[140:143], v63, s[16:19], s76 offen sc1
    s_add_u32 s76, s76, 4608
L_rp_16:
    s_and_b32 s3, vcc_lo, 3072
    s_cbranch_scc0 L_rok_17
    buffer_load_dwordx2 v[236:237], v238, s[16:19], 0 offen sc1
    s_waitcnt vmcnt(0)
    v_cmp_ne_u64 vcc, s[62:63], v[236:237]
    s_sub_u32 s5, s5, 1
    s_cmp_gt_i32 s5, 0
    s_nop 2
    s_cbranch_scc1 L_rp_16
L_rok_17:
    buffer_load_dwordx4 v[144:147], v60, s[16:19], s76 offen sc1
    buffer_load_dwordx4 v[148:151], v61, s[16:19], s76 offen sc1
    buffer_load_dwordx4 v[152:155], v62, s[16:19], s76 offen sc1
    buffer_load_dwordx4 v[156:159], v63, s[16:19], s76 offen sc1
    s_add_u32 s76, s76, 4608
L_rp_18:
    s_and_b32 s3, vcc_lo, 12288
    s_cbranch_scc0 L_rok_19
    buffer_load_dwordx2 v[236:237], v238, s[16:19], 0 offen sc1
    s_waitcnt vmcnt(0)
    v_cmp_ne_u64 vcc, s[62:63], v[236:237]
    s_sub_u32 s5, s5, 1
    s_cmp_gt_i32 s5, 0
    s_nop 2
    s_cbranch_scc1 L_rp_18
L_rok_19:
    buffer_load_dwordx4 v[160:163], v60, s[16:19], s76 offen sc1
    buffer_load_dwordx4 v[164:167], v61, s[16:19], s76 offen sc1
    buffer_load_dwordx4 v[168:171], v62, s[16:19], s76 offen sc1
    buffer_load_dwordx4 v[172:175], v63, s[16:19], s76 offen sc1
    s_add_u32 s76, s76, 4608
L_rp_20:
    s_and_b32 s3, vcc_lo, 49152
    s_cbranch_scc0 L_rok_21
    buffer_load_dwordx2 v[236:237], v238, s[16:19], 0 offen sc1
    s_waitcnt vmcnt(0)
    v_cmp_ne_u64 vcc, s[62:63], v[236:237]
    s_sub_u32 s5, s5, 1
    s_cmp_gt_i32 s5, 0
    s_nop 2
    s_cbranch_scc1 L_rp_20
L_rok_21:
    buffer_load_dwordx4 v[176:179], v60, s[16:19], s76 offen sc1
    buffer_load_dwordx4 v[180:183], v61, s[16:19], s76 offen sc1
    buffer_load_dwordx4 v[184:187], v62, s[16:19], s76 offen sc1
    buffer_load_dwordx4 v[188:191], v63, s[16:19], s76 offen sc1
    s_add_u32 s76, s76, 4608
    s_waitcnt vmcnt(24)
    v_pk_add_f32 v[64:65], v[64:65], v[80:81]
    v_pk_add_f32 v[66:67], v[66:67], v[82:83]
    v_pk_add_f32 v[68:69], v[68:69], v[84:85]
    v_pk_add_f32 v[70:71], v[70:71], v[86:87]
    v_pk_add_f32 v[72:73], v[72:73], v[88:89]
    v_pk_add_f32 v[74:75], v[74:75], v[90:91]
    v_pk_add_f32 v[76:77], v[76:77], v[92:93]
    v_pk_add_f32 v[78:79], v[78:79], v[94:95]
    s_waitcnt vmcnt(20)
    v_pk_add_f32 v[64:65], v[64:65], v[96:97]
    v_pk_add_f32 v[66:67], v[66:67], v[98:99]
    v_pk_add_f32 v[68:69], v[68:69], v[100:101]
    v_pk_add_f32 v[70:71], v[70:71], v[102:103]
    v_pk_add_f32 v[72:73], v[72:73], v[104:105]
    v_pk_add_f32 v[74:75], v[74:75], v[106:107]
    v_pk_add_f32 v[76:77], v[76:77], v[108:109]
    v_pk_add_f32 v[78:79], v[78:79], v[110:111]
    s_waitcnt vmcnt(16)
    v_pk_add_f32 v[64:65], v[64:65], v[112:113]
    v_pk_add_f32 v[66:67], v[66:67], v[114:115]
    v_pk_add_f32 v[68:69], v[68:69], v[116:117]
    v_pk_add_f32 v[70:71], v[70:71], v[118:119]
    v_pk_add_f32 v[72:73], v[72:73], v[120:121]
    v_pk_add_f32 v[74:75], v[74:75], v[122:123]
    v_pk_add_f32 v[76:77], v[76:77], v[124:125]
    v_pk_add_f32 v[78:79], v[78:79], v[126:127]
    s_waitcnt vmcnt(12)
    v_pk_add_f32 v[64:65], v[64:65], v[128:129]
    v_pk_add_f32 v[66:67], v[66:67], v[130:131]
    v_pk_add_f32 v[68:69], v[68:69], v[132:133]
    v_pk_add_f32 v[70:71], v[70:71], v[134:135]
    v_pk_add_f32 v[72:73], v[72:73], v[136:137]
    v_pk_add_f32 v[74:75], v[74:75], v[138:139]
    v_pk_add_f32 v[76:77], v[76:77], v[140:141]
    v_pk_add_f32 v[78:79], v[78:79], v[142:143]
    s_waitcnt vmcnt(8)
    v_pk_add_f32 v[64:65], v[64:65], v[144:145]
    v_pk_add_f32 v[66:67], v[66:67], v[146:147]
    v_pk_add_f32 v[68:69], v[68:69], v[148:149]
    v_pk_add_f32 v[70:71], v[70:71], v[150:151]
    v_pk_add_f32 v[72:73], v[72:73], v[152:153]
    v_pk_add_f32 v[74:75], v[74:75], v[154:155]
    v_pk_add_f32 v[76:77], v[76:77], v[156:157]
    v_pk_add_f32 v[78:79], v[78:79], v[158:159]
    s_waitcnt vmcnt(4)
    v_pk_add_f32 v[64:65], v[64:65], v[160:161]
    v_pk_add_f32 v[66:67], v[66:67], v[162:163]
    v_pk_add_f32 v[68:69], v[68:69], v[164:165]
    v_pk_add_f32 v[70:71], v[70:71], v[166:167]
    v_pk_add_f32 v[72:73], v[72:73], v[168:169]
    v_pk_add_f32 v[74:75], v[74:75], v[170:171]
    v_pk_add_f32 v[76:77], v[76:77], v[172:173]
    v_pk_add_f32 v[78:79], v[78:79], v[174:175]
    s_waitcnt vmcnt(0)
    v_pk_add_f32 v[64:65], v[64:65], v[176:177]
    v_pk_add_f32 v[66:67], v[66:67], v[178:179]
    v_pk_add_f32 v[68:69], v[68:69], v[180:181]
    v_pk_add_f32 v[70:71], v[70:71], v[182:183]
    v_pk_add_f32 v[72:73], v[72:73], v[184:185]
    v_pk_add_f32 v[74:75], v[74:75], v[186:187]
    v_pk_add_f32 v[76:77], v[76:77], v[188:189]
    v_pk_add_f32 v[78:79], v[78:79], v[190:191]
    ds_write_b128 v233, v[64:67] offset:0
    ds_write_b128 v233, v[68:71] offset:1024
    ds_write_b128 v233, v[72:75] offset:2048
    ds_write_b128 v233, v[76:79] offset:3072
    s_waitcnt lgkmcnt(0)
    s_barrier
    s_lshl_b32 s3, s24, 11
    s_and_b32 s3, s3, 2048
    v_add_u32 v6, s3, v5
    ds_read_b128 v[64:67], v6 offset:0
    ds_read_b128 v[68:71], v6 offset:1024
    ds_read_b128 v[72:75], v6 offset:8192
    ds_read_b128 v[76:79], v6 offset:9216
    ds_read_b128 v[80:83], v6 offset:16384
    ds_read_b128 v[84:87], v6 offset:17408
    ds_read_b128 v[88:91], v6 offset:24576
    ds_read_b128 v[92:95], v6 offset:25600
    s_waitcnt lgkmcnt(0)
    s_barrier
    v_add_f32 v64, v64, v72
    v_add_f32 v65, v65, v73
    v_add_f32 v66, v66, v74
    v_add_f32 v67, v67, v75
    v_add_f32 v68, v68, v76
    v_add_f32 v69, v69, v77
    v_add_f32 v70, v70, v78
    v_add_f32 v71, v71, v79
    v_add_f32 v64, v64, v80
    v_add_f32 v65, v65, v81
    v_add_f32 v66, v66, v82
    v_add_f32 v67, v67, v83
    v_add_f32 v68, v68, v84
    v_add_f32 v69, v69, v85
    v_add_f32 v70, v70, v86
    v_add_f32 v71, v71, v87
    v_add_f32 v64, v64, v88
    v_add_f32 v65, v65, v89
    v_add_f32 v66, v66, v90
    v_add_f32 v67, v67, v91
    v_add_f32 v68, v68, v92
    v_add_f32 v69, v69, v93
    v_add_f32 v70, v70, v94
    v_add_f32 v71, v71, v95
    v_add_f32_dpp v64, v64, v64 row_ror:8 row_mask:0xa bank_mask:0xf
    v_add_f32_dpp v65, v65, v65 row_ror:8 row_mask:0xa bank_mask:0xf
    v_add_f32_dpp v66, v66, v66 row_ror:8 row_mask:0xa bank_mask:0xf
    v_add_f32_dpp v67, v67, v67 row_ror:8 row_mask:0xa bank_mask:0xf
    v_add_f32_dpp v68, v68, v68 row_ror:8 row_mask:0xa bank_mask:0xf
    v_add_f32_dpp v69, v69, v69 row_ror:8 row_mask:0xa bank_mask:0xf
    v_add_f32_dpp v70, v70, v70 row_ror:8 row_mask:0xa bank_mask:0xf
    v_add_f32_dpp v71, v71, v71 row_ror:8 row_mask:0xa bank_mask:0xf
    v_cvt_pk_bf16_f32 v72, v64, v65
    v_cvt_pk_bf16_f32 v73, v66, v67
    v_cvt_pk_bf16_f32 v74, v68, v69
    v_cvt_pk_bf16_f32 v75, v70, v71
    s_lshl_b32 s3, s34, 1
    s_and_b32 s7, s24, 1
    s_add_u32 s3, s3, s7
    s_lshr_b32 s7, s24, 1
    s_lshl_b32 s4, s3, 10
    s_lshl_b32 s5, s7, 16
    s_add_u32 s4, s4, s5
    s_add_u32 s4, s4, 65536
    s_lshl_b32 s3, s3, 7
    s_lshl_b32 s5, s7, 13
    s_add_u32 s3, s3, s5
    s_add_u32 s77, s3, 196608
    buffer_store_dwordx4 v[72:75], v5, s[16:19], s4 offen sc1
    s_waitcnt vmcnt(0) lgkmcnt(0)
    v_mov_b32 v2, s62
    v_mov_b32 v3, s63
    v_mov_b32 v4, 0
    s_mov_b64 exec, 1
    buffer_store_dwordx2 v[2:3], v4, s[16:19], s77 offen sc1
    s_mov_b64 exec, -1
L_join:
    s_nop 3
    v_mfma_f32_32x32x16_bf16 v[64:79], v[248:251], v[240:243], 0
    v_mfma_f32_32x32x16_bf16 v[64:79], v[252:255], v[244:247], v[64:79]
    s_lshr_b32 s3, s24, 1
    s_lshl_b32 s3, s3, 6
    v_xor_b32 v7, s3, v8
    v_lshl_add_u32 v7, v9, 9, v7
    v_add_u32 v226, s75, v7
    v_xor_b32 v227, 64, v226
    v_add_u32 v228, 0x10000, v226
    v_add_u32 v229, 0x10000, v227
    v_add_u32 v230, 0x20000, v226
    v_add_u32 v231, 0x20000, v227
    s_nop 1
    v_max3_f32 v112, v64, v65, v66
    v_max3_f32 v113, v72, v73, v74
    v_min3_f32 v114, v64, v65, v66
    v_min3_f32 v115, v72, v73, v74
    v_max3_f32 v112, v112, v67, v68
    v_max3_f32 v113, v113, v75, v76
    v_min3_f32 v114, v114, v67, v68
    v_min3_f32 v115, v115, v75, v76
    v_max3_f32 v112, v112, v69, v70
    v_max3_f32 v113, v113, v77, v78
    v_min3_f32 v114, v114, v69, v70
    v_min3_f32 v115, v115, v77, v78
    s_and_b32 s4, s70, 15
    s_lshr_b64 s[70:71], s[70:71], 4
    s_add_u32 m0, s75, 135168
    s_lshl_b32 s4, s4, 17
    s_add_u32 s4, s4, s32
    buffer_load_dwordx4 v18, s[8:11], s4 offen offset:0 lds
    v_max_f32 v112, v112, v71
    v_max_f32 v113, v113, v79
    v_min_f32 v114, v114, v71
    v_min_f32 v115, v115, v79
    v_permlane32_swap_b32 v112, v113
    s_nop 0
    v_permlane32_swap_b32 v114, v115
    v_max_f32 v112, v112, v113
    v_min_f32 v114, v114, v115
    v_mul_f32 v112, s74, v112
    v_mul_f32 v114, s74, v114
    v_mov_b32 v113, v112
    v_mov_b32 v115, v114
    buffer_load_dwordx4 v19, s[8:11], s4 offen offset:1024 lds
    v_permlane32_swap_b32 v112, v113
    v_permlane32_swap_b32 v114, v115
    v_pk_fma_f32 v[80:81], v[64:65], s[74:75], v[112:113] op_sel:[0,0,0] op_sel_hi:[1,0,0] neg_lo:[0,0,1] neg_hi:[0,0,1]
    v_pk_fma_f32 v[88:89], v[64:65], s[74:75], v[114:115] op_sel:[0,0,0] op_sel_hi:[1,0,0] neg_lo:[1,0,0] neg_hi:[1,0,0]
    v_pk_fma_f32 v[82:83], v[66:67], s[74:75], v[112:113] op_sel:[0,0,0] op_sel_hi:[1,0,0] neg_lo:[0,0,1] neg_hi:[0,0,1]
    v_pk_fma_f32 v[90:91], v[66:67], s[74:75], v[114:115] op_sel:[0,0,0] op_sel_hi:[1,0,0] neg_lo:[1,0,0] neg_hi:[1,0,0]
    v_pk_fma_f32 v[84:85], v[68:69], s[74:75], v[112:113] op_sel:[0,0,0] op_sel_hi:[1,0,0] neg_lo:[0,0,1] neg_hi:[0,0,1]
    v_pk_fma_f32 v[92:93], v[68:69], s[74:75], v[114:115] op_sel:[0,0,0] op_sel_hi:[1,0,0] neg_lo:[1,0,0] neg_hi:[1,0,0]
    v_pk_fma_f32 v[86:87], v[70:71], s[74:75], v[112:113] op_sel:[0,0,0] op_sel_hi:[1,0,0] neg_lo:[0,0,1] neg_hi:[0,0,1]
    v_pk_fma_f32 v[94:95], v[70:71], s[74:75], v[114:115] op_sel:[0,0,0] op_sel_hi:[1,0,0] neg_lo:[1,0,0] neg_hi:[1,0,0]
    v_exp_f32 v80, v80
    buffer_load_dwordx4 v20, s[8:11], s4 offen offset:2048 lds
    v_exp_f32 v81, v81
    v_exp_f32 v82, v82
    v_exp_f32 v83, v83
    v_exp_f32 v84, v84
    v_exp_f32 v85, v85
    v_exp_f32 v86, v86
    buffer_load_dwordx4 v21, s[8:11], s4 offen offset:3072 lds
    v_exp_f32 v87, v87
    v_exp_f32 v88, v88
    v_exp_f32 v89, v89
    v_exp_f32 v90, v90
    v_exp_f32 v91, v91
    v_exp_f32 v92, v92
    s_waitcnt vmcnt(18)
    ds_read_b64_tr_b16 a[0:1], v24 offset:36864
    ds_read_b64_tr_b16 a[2:3], v24 offset:37888
    ds_read_b64_tr_b16 a[4:5], v25 offset:36864
    ds_read_b64_tr_b16 a[6:7], v25 offset:37888
    v_exp_f32 v93, v93
    v_exp_f32 v94, v94
    v_exp_f32 v95, v95
    s_waitcnt vmcnt(4)
    s_barrier
    s_cmp_lg_u32 s24, 0
    s_cbranch_scc1 L_nf_22
    v_mov_b32 v2, s62
    v_mov_b32 v3, s63
    v_mov_b32 v4, 0
    s_mov_b64 exec, 1
    buffer_store_dwordx2 v[2:3], v4, s[16:19], s77 offen sc1
    s_mov_b64 exec, -1
L_nf_22:
    v_pk_fma_f32 v[96:97], v[72:73], s[74:75], v[112:113] op_sel:[0,0,1] op_sel_hi:[1,0,1] neg_lo:[0,0,1] neg_hi:[0,0,1]
    ds_read_b64_tr_b16 a[8:9], v24 offset:38912
    ds_read_b64_tr_b16 a[10:11], v24 offset:39936
    ds_read_b64_tr_b16 a[12:13], v25 offset:38912
    ds_read_b64_tr_b16 a[14:15], v25 offset:39936
    v_pk_fma_f32 v[104:105], v[72:73], s[74:75], v[114:115] op_sel:[0,0,1] op_sel_hi:[1,0,1] neg_lo:[1,0,0] neg_hi:[1,0,0]
    v_pk_fma_f32 v[98:99], v[74:75], s[74:75], v[112:113] op_sel:[0,0,1] op_sel_hi:[1,0,1] neg_lo:[0,0,1] neg_hi:[0,0,1]
    v_pk_fma_f32 v[106:107], v[74:75], s[74:75], v[114:115] op_sel:[0,0,1] op_sel_hi:[1,0,1] neg_lo:[1,0,0] neg_hi:[1,0,0]
    s_and_b32 s4, s70, 15
    s_lshr_b64 s[70:71], s[70:71], 4
    s_add_u32 m0, s75, 65536
    s_lshl_b32 s4, s4, 17
    s_add_u32 s4, s4, s32
    buffer_load_dwordx4 v18, s[8:11], s4 offen offset:0 lds
    v_pk_fma_f32 v[100:101], v[76:77], s[74:75], v[112:113] op_sel:[0,0,1] op_sel_hi:[1,0,1] neg_lo:[0,0,1] neg_hi:[0,0,1]
    v_pk_fma_f32 v[108:109], v[76:77], s[74:75], v[114:115] op_sel:[0,0,1] op_sel_hi:[1,0,1] neg_lo:[1,0,0] neg_hi:[1,0,0]
    v_pk_fma_f32 v[102:103], v[78:79], s[74:75], v[112:113] op_sel:[0,0,1] op_sel_hi:[1,0,1] neg_lo:[0,0,1] neg_hi:[0,0,1]
    buffer_load_dwordx4 v19, s[8:11], s4 offen offset:1024 lds
    v_pk_fma_f32 v[110:111], v[78:79], s[74:75], v[114:115] op_sel:[0,0,1] op_sel_hi:[1,0,1] neg_lo:[1,0,0] neg_hi:[1,0,0]
    v_exp_f32 v96, v96
    buffer_load_dwordx4 v20, s[8:11], s4 offen offset:2048 lds
    v_exp_f32 v97, v97
    v_exp_f32 v98, v98
    buffer_load_dwordx4 v21, s[8:11], s4 offen offset:3072 lds
    v_exp_f32 v99, v99
    v_exp_f32 v100, v100
    ds_read_b64_tr_b16 a[16:17], v26 offset:32768
    ds_read_b64_tr_b16 a[18:19], v26 offset:33792
    ds_read_b64_tr_b16 a[20:21], v27 offset:32768
    ds_read_b64_tr_b16 a[22:23], v27 offset:33792
    v_exp_f32 v101, v101
    v_exp_f32 v102, v102
    ds_read_b64_tr_b16 a[24:25], v26 offset:34816
    ds_read_b64_tr_b16 a[26:27], v26 offset:35840
    ds_read_b64_tr_b16 a[28:29], v27 offset:34816
    ds_read_b64_tr_b16 a[30:31], v27 offset:35840
    v_exp_f32 v103, v103
    v_exp_f32 v104, v104
    s_and_b32 s4, s70, 15
    s_lshr_b64 s[70:71], s[70:71], 4
    s_add_u32 m0, s75, 69632
    s_lshl_b32 s4, s4, 17
    s_add_u32 s4, s4, s32
    buffer_load_dwordx4 v18, s[8:11], s4 offen offset:0 lds
    v_exp_f32 v105, v105
    v_exp_f32 v106, v106
    buffer_load_dwordx4 v19, s[8:11], s4 offen offset:1024 lds
    v_exp_f32 v107, v107
    v_exp_f32 v108, v108
    buffer_load_dwordx4 v20, s[8:11], s4 offen offset:2048 lds
    v_exp_f32 v109, v109
    v_exp_f32 v110, v110
    buffer_load_dwordx4 v21, s[8:11], s4 offen offset:3072 lds
    v_exp_f32 v111, v111
    v_pk_add_f32 v[120:121], v[80:81], v[82:83]
    ds_read_b64_tr_b16 a[32:33], v28 offset:0
    ds_read_b64_tr_b16 a[34:35], v28 offset:1024
    ds_read_b64_tr_b16 a[36:37], v29 offset:0
    ds_read_b64_tr_b16 a[38:39], v29 offset:1024
    v_pk_add_f32 v[122:123], v[88:89], v[90:91]
    v_pk_add_f32 v[124:125], v[96:97], v[98:99]
    v_pk_add_f32 v[126:127], v[104:105], v[106:107]
    ds_read_b64_tr_b16 a[40:41], v28 offset:2048
    ds_read_b64_tr_b16 a[42:43], v28 offset:3072
    ds_read_b64_tr_b16 a[44:45], v29 offset:2048
    ds_read_b64_tr_b16 a[46:47], v29 offset:3072
    v_pk_add_f32 v[120:121], v[120:121], v[84:85]
    v_pk_add_f32 v[122:123], v[122:123], v[92:93]
    v_pk_add_f32 v[124:125], v[124:125], v[100:101]
    s_and_b32 s4, s70, 15
    s_lshr_b64 s[70:71], s[70:71], 4
    s_add_u32 m0, s75, 0
    s_lshl_b32 s4, s4, 17
    s_add_u32 s4, s4, s32
    buffer_load_dwordx4 v18, s[8:11], s4 offen offset:0 lds
    v_pk_add_f32 v[126:127], v[126:127], v[108:109]
    v_pk_add_f32 v[120:121], v[120:121], v[86:87]
    v_pk_add_f32 v[122:123], v[122:123], v[94:95]
    buffer_load_dwordx4 v19, s[8:11], s4 offen offset:1024 lds
    v_pk_add_f32 v[124:125], v[124:125], v[102:103]
    v_pk_add_f32 v[126:127], v[126:127], v[110:111]
    v_add_f32 v116, v120, v121
    buffer_load_dwordx4 v20, s[8:11], s4 offen offset:2048 lds
    v_add_f32 v117, v122, v123
    v_add_f32 v118, v124, v125
    v_add_f32 v119, v126, v127
    buffer_load_dwordx4 v21, s[8:11], s4 offen offset:3072 lds
    v_permlane32_swap_b32 v116, v117
    v_permlane32_swap_b32 v118, v119
    v_add_f32 v116, v116, v117
    s_waitcnt vmcnt(12)
    ds_read_b64_tr_b16 a[48:49], v28 offset:4096
    ds_read_b64_tr_b16 a[50:51], v28 offset:5120
    ds_read_b64_tr_b16 a[52:53], v29 offset:4096
    ds_read_b64_tr_b16 a[54:55], v29 offset:5120
    v_add_f32 v118, v118, v119
    v_rcp_f32 v116, v116
    ds_read_b64_tr_b16 a[56:57], v28 offset:6144
    ds_read_b64_tr_b16 a[58:59], v28 offset:7168
    ds_read_b64_tr_b16 a[60:61], v29 offset:6144
    ds_read_b64_tr_b16 a[62:63], v29 offset:7168
    v_rcp_f32 v118, v118
    v_mov_b32 v117, v116
    s_and_b32 s4, s70, 15
    s_lshr_b64 s[70:71], s[70:71], 4
    s_add_u32 m0, s75, 4096
    s_lshl_b32 s4, s4, 17
    s_add_u32 s4, s4, s32
    buffer_load_dwordx4 v18, s[8:11], s4 offen offset:0 lds
    v_mov_b32 v119, v118
    v_permlane32_swap_b32 v116, v117
    s_nop 0
    v_permlane32_swap_b32 v118, v119
    buffer_load_dwordx4 v19, s[8:11], s4 offen offset:1024 lds
    v_pk_mul_f32 v[80:81], v[80:81], v[116:117] op_sel:[0,0] op_sel_hi:[1,0]
    v_pk_mul_f32 v[82:83], v[82:83], v[116:117] op_sel:[0,0] op_sel_hi:[1,0]
    v_pk_mul_f32 v[84:85], v[84:85], v[116:117] op_sel:[0,0] op_sel_hi:[1,0]
    buffer_load_dwordx4 v20, s[8:11], s4 offen offset:2048 lds
    v_pk_mul_f32 v[86:87], v[86:87], v[116:117] op_sel:[0,0] op_sel_hi:[1,0]
    v_cvt_pk_bf16_f32 v48, v80, v81
    v_cvt_pk_bf16_f32 v49, v82, v83
    buffer_load_dwordx4 v21, s[8:11], s4 offen offset:3072 lds
    v_cvt_pk_bf16_f32 v50, v84, v85
    v_cvt_pk_bf16_f32 v51, v86, v87
    v_pk_mul_f32 v[88:89], v[88:89], v[116:117] op_sel:[0,1] op_sel_hi:[1,1]
    s_waitcnt vmcnt(12)
    ds_read_b64_tr_b16 a[64:65], v26 offset:0
    ds_read_b64_tr_b16 a[66:67], v26 offset:1024
    ds_read_b64_tr_b16 a[68:69], v27 offset:0
    ds_read_b64_tr_b16 a[70:71], v27 offset:1024
    v_pk_mul_f32 v[90:91], v[90:91], v[116:117] op_sel:[0,1] op_sel_hi:[1,1]
    v_pk_mul_f32 v[92:93], v[92:93], v[116:117] op_sel:[0,1] op_sel_hi:[1,1]
    v_pk_mul_f32 v[94:95], v[94:95], v[116:117] op_sel:[0,1] op_sel_hi:[1,1]
    ds_read_b64_tr_b16 a[72:73], v26 offset:2048
    ds_read_b64_tr_b16 a[74:75], v26 offset:3072
    ds_read_b64_tr_b16 a[76:77], v27 offset:2048
    ds_read_b64_tr_b16 a[78:79], v27 offset:3072
    v_cvt_pk_bf16_f32 v52, v88, v89
    v_cvt_pk_bf16_f32 v53, v90, v91
    v_cvt_pk_bf16_f32 v54, v92, v93
    v_cvt_pk_bf16_f32 v55, v94, v95
    v_pk_mul_f32 v[96:97], v[96:97], v[118:119] op_sel:[0,0] op_sel_hi:[1,0]
    v_pk_mul_f32 v[98:99], v[98:99], v[118:119] op_sel:[0,0] op_sel_hi:[1,0]
    v_pk_mul_f32 v[100:101], v[100:101], v[118:119] op_sel:[0,0] op_sel_hi:[1,0]
    v_pk_mul_f32 v[102:103], v[102:103], v[118:119] op_sel:[0,0] op_sel_hi:[1,0]
    v_cvt_pk_bf16_f32 v56, v96, v97
    v_cvt_pk_bf16_f32 v57, v98, v99
    v_cvt_pk_bf16_f32 v58, v100, v101
    v_cvt_pk_bf16_f32 v59, v102, v103
    v_pk_mul_f32 v[104:105], v[104:105], v[118:119] op_sel:[0,1] op_sel_hi:[1,1]
    v_pk_mul_f32 v[106:107], v[106:107], v[118:119] op_sel:[0,1] op_sel_hi:[1,1]
    v_pk_mul_f32 v[108:109], v[108:109], v[118:119] op_sel:[0,1] op_sel_hi:[1,1]
    v_pk_mul_f32 v[110:111], v[110:111], v[118:119] op_sel:[0,1] op_sel_hi:[1,1]
    v_cvt_pk_bf16_f32 v60, v104, v105
    v_cvt_pk_bf16_f32 v61, v106, v107
    v_cvt_pk_bf16_f32 v62, v108, v109
    v_cvt_pk_bf16_f32 v63, v110, v111
    s_and_b32 s3, s24, 1
    s_lshl_b32 s3, s3, 9
    s_lshl_b32 s7, s26, 10
    s_add_u32 s3, s3, s7
    s_add_u32 s3, s3, 196608
    v_and_b32 v7, 3, v1
    v_lshl_add_u32 v214, v7, 7, s3
    s_mul_i32 s3, s27, 3584
    s_mul_i32 s7, s24, 896
    s_add_u32 s3, s3, s7
    s_add_u32 s3, s3, 524288
    v_min_u32 v6, 6, v1
    v_lshl_add_u32 v238, v6, 7, s3
    s_mul_i32 s58, s24, 57344
    s_mul_i32 s3, s27, 229376
    s_add_u32 s58, s58, s3
    s_add_u32 s58, s58, 8396800
    s_lshl_b32 s59, s24, 14
    s_lshl_b32 s3, s31, 16
    s_add_u32 s59, s59, s3
    s_add_u32 s59, s59, 6295552
    s_lshr_b32 s3, s24, 1
    s_lshl_b32 s3, s3, 10
    v_add_u32 v30, s3, v5
    v_xor_b32 v31, 0x400, v30
    s_mov_b32 s20, s56
    s_mov_b32 s21, s57
    s_mov_b32 s22, 2097152
    s_mov_b32 s23, 0x00020000
    s_and_b32 s4, s70, 15
    s_lshr_b64 s[70:71], s[70:71], 4
    s_add_u32 m0, s75, 32768
    s_lshl_b32 s4, s4, 17
    s_add_u32 s4, s4, s32
    buffer_load_dwordx4 v18, s[8:11], s4 offen offset:0 lds
    buffer_load_dwordx4 v19, s[8:11], s4 offen offset:1024 lds
    buffer_load_dwordx4 v20, s[8:11], s4 offen offset:2048 lds
    buffer_load_dwordx4 v21, s[8:11], s4 offen offset:3072 lds
    s_waitcnt vmcnt(12)
    ds_read_b64_tr_b16 a[80:81], v26 offset:4096
    ds_read_b64_tr_b16 a[82:83], v26 offset:5120
    ds_read_b64_tr_b16 a[84:85], v27 offset:4096
    ds_read_b64_tr_b16 a[86:87], v27 offset:5120
    ds_read_b64_tr_b16 a[88:89], v26 offset:6144
    ds_read_b64_tr_b16 a[90:91], v26 offset:7168
    ds_read_b64_tr_b16 a[92:93], v27 offset:6144
    ds_read_b64_tr_b16 a[94:95], v27 offset:7168
    s_waitcnt lgkmcnt(15)
    s_and_b32 s4, s70, 15
    s_lshr_b64 s[70:71], s[70:71], 4
    s_add_u32 m0, s75, 36864
    s_lshl_b32 s4, s4, 17
    s_add_u32 s4, s4, s32
    buffer_load_dwordx4 v18, s[8:11], s4 offen offset:0 lds
    buffer_load_dwordx4 v19, s[8:11], s4 offen offset:1024 lds
    buffer_load_dwordx4 v20, s[8:11], s4 offen offset:2048 lds
    buffer_load_dwordx4 v21, s[8:11], s4 offen offset:3072 lds
    s_waitcnt vmcnt(12)
    ds_read_b64_tr_b16 a[96:97], v24 offset:0
    ds_read_b64_tr_b16 a[98:99], v24 offset:1024
    ds_read_b64_tr_b16 a[100:101], v25 offset:0
    ds_read_b64_tr_b16 a[102:103], v25 offset:1024
    ds_read_b64_tr_b16 a[104:105], v24 offset:2048
    ds_read_b64_tr_b16 a[106:107], v24 offset:3072
    ds_read_b64_tr_b16 a[108:109], v25 offset:2048
    ds_read_b64_tr_b16 a[110:111], v25 offset:3072
    s_and_b32 s4, s70, 15
    s_lshr_b64 s[70:71], s[70:71], 4
    s_add_u32 m0, s75, 98304
    s_lshl_b32 s4, s4, 17
    s_add_u32 s4, s4, s32
    buffer_load_dwordx4 v18, s[8:11], s4 offen offset:0 lds
    buffer_load_dwordx4 v19, s[8:11], s4 offen offset:1024 lds
    buffer_load_dwordx4 v20, s[8:11], s4 offen offset:2048 lds
    buffer_load_dwordx4 v21, s[8:11], s4 offen offset:3072 lds
    s_waitcnt vmcnt(12)
    ds_read_b64_tr_b16 a[112:113], v24 offset:4096
    ds_read_b64_tr_b16 a[114:115], v24 offset:5120
    ds_read_b64_tr_b16 a[116:117], v25 offset:4096
    ds_read_b64_tr_b16 a[118:119], v25 offset:5120
    ds_read_b64_tr_b16 a[120:121], v24 offset:6144
    ds_read_b64_tr_b16 a[122:123], v24 offset:7168
    ds_read_b64_tr_b16 a[124:125], v25 offset:6144
    ds_read_b64_tr_b16 a[126:127], v25 offset:7168
    s_and_b32 s4, s70, 15
    s_lshr_b64 s[70:71], s[70:71], 4
    s_add_u32 m0, s75, 131072
    s_lshl_b32 s4, s4, 17
    s_add_u32 s4, s4, s32
    buffer_load_dwordx4 v18, s[8:11], s4 offen offset:0 lds
    buffer_load_dwordx4 v19, s[8:11], s4 offen offset:1024 lds
    buffer_load_dwordx4 v20, s[8:11], s4 offen offset:2048 lds
    buffer_load_dwordx4 v21, s[8:11], s4 offen offset:3072 lds
    s_waitcnt vmcnt(12)
    ds_read_b64_tr_b16 a[128:129], v24 offset:32768
    ds_read_b64_tr_b16 a[130:131], v24 offset:33792
    ds_read_b64_tr_b16 a[132:133], v25 offset:32768
    ds_read_b64_tr_b16 a[134:135], v25 offset:33792
    ds_read_b64_tr_b16 a[136:137], v24 offset:34816
    ds_read_b64_tr_b16 a[138:139], v24 offset:35840
    ds_read_b64_tr_b16 a[140:141], v25 offset:34816
    ds_read_b64_tr_b16 a[142:143], v25 offset:35840
    buffer_load_dwordx2 v[212:213], v214, s[16:19], 0 offen sc1
    buffer_load_dwordx2 v[236:237], v238, s[16:19], 0 offen sc1
    s_and_b32 s4, s70, 15
    s_lshr_b64 s[70:71], s[70:71], 4
    s_add_u32 m0, s75, 135168
    s_lshl_b32 s4, s4, 17
    s_add_u32 s4, s4, s32
    buffer_load_dwordx4 v18, s[8:11], s4 offen offset:0 lds
    buffer_load_dwordx4 v19, s[8:11], s4 offen offset:1024 lds
    buffer_load_dwordx4 v20, s[8:11], s4 offen offset:2048 lds
    buffer_load_dwordx4 v21, s[8:11], s4 offen offset:3072 lds
    s_waitcnt vmcnt(14)
    ds_read_b64_tr_b16 a[144:145], v24 offset:36864
    ds_read_b64_tr_b16 a[146:147], v24 offset:37888
    ds_read_b64_tr_b16 a[148:149], v25 offset:36864
    ds_read_b64_tr_b16 a[150:151], v25 offset:37888
    ds_read_b64_tr_b16 a[152:153], v24 offset:38912
    ds_read_b64_tr_b16 a[154:155], v24 offset:39936
    ds_read_b64_tr_b16 a[156:157], v25 offset:38912
    ds_read_b64_tr_b16 a[158:159], v25 offset:39936
    s_waitcnt lgkmcnt(15)
    s_and_b32 s4, s70, 15
    s_lshr_b64 s[70:71], s[70:71], 4
    s_add_u32 m0, s75, 65536
    s_lshl_b32 s4, s4, 17
    s_add_u32 s4, s4, s32
    buffer_load_dwordx4 v18, s[8:11], s4 offen offset:0 lds
    buffer_load_dwordx4 v19, s[8:11], s4 offen offset:1024 lds
    buffer_load_dwordx4 v20, s[8:11], s4 offen offset:2048 lds
    buffer_load_dwordx4 v21, s[8:11], s4 offen offset:3072 lds
    s_waitcnt vmcnt(14)
    ds_read_b64_tr_b16 a[160:161], v26 offset:32768
    ds_read_b64_tr_b16 a[162:163], v26 offset:33792
    ds_read_b64_tr_b16 a[164:165], v27 offset:32768
    ds_read_b64_tr_b16 a[166:167], v27 offset:33792
    ds_read_b64_tr_b16 a[168:169], v26 offset:34816
    ds_read_b64_tr_b16 a[170:171], v26 offset:35840
    ds_read_b64_tr_b16 a[172:173], v27 offset:34816
    ds_read_b64_tr_b16 a[174:175], v27 offset:35840
    s_waitcnt vmcnt(9)
    v_cmp_ne_u64 vcc, s[62:63], v[212:213]
    s_nop 4
    s_cbranch_vccz L_ok_23
    s_mov_b32 s3, 50000
L_spin_24:
    s_sleep 2
    buffer_load_dwordx2 v[212:213], v214, s[16:19], 0 offen sc1
    s_waitcnt vmcnt(0)
    v_cmp_ne_u64 vcc, s[62:63], v[212:213]
    s_sub_u32 s3, s3, 1
    s_cmp_eq_u32 s3, 0
    s_cbranch_scc1 L_ok_23
    s_nop 2
    s_cbranch_vccnz L_spin_24
L_ok_23:
    s_and_b32 s3, s24, 1
    s_lshl_b32 s3, s3, 1
    s_lshl_b32 s7, s26, 2
    s_add_u32 s5, s3, s7
    s_lshl_b32 s3, s5, 11
    s_add_u32 s3, s3, 65536
    buffer_load_dwordx4 v[32:35], v5, s[16:19], s3 offen offset:0 sc1
    buffer_load_dwordx4 v[36:39], v5, s[16:19], s3 offen offset:1024 sc1
    buffer_load_dwordx4 v[40:43], v5, s[16:19], s3 offen offset:2048 sc1
    buffer_load_dwordx4 v[44:47], v5, s[16:19], s3 offen offset:3072 sc1
    s_lshr_b32 s7, s24, 1
    s_lshl_b32 s3, s25, 16
    s_lshl_b32 s5, s5, 11
    s_add_u32 s3, s3, s5
    s_lshl_b32 s7, s7, 10
    s_add_u32 s3, s3, s7
    s_add_u32 s76, s3, 6295552
    s_lshl_b32 s3, s25, 3
    s_add_u32 s3, s3, s26
    s_lshl_b32 s3, s3, 7
    s_add_u32 s77, s3, 655360
    s_waitcnt vmcnt(12)
    v_cmp_ne_u64 vcc, s[62:63], v[236:237]
    s_nop 4
    s_cbranch_vccz L_ok_25
    s_mov_b32 s3, 50000
L_spin_26:
    s_sleep 2
    buffer_load_dwordx2 v[236:237], v238, s[16:19], 0 offen sc1
    s_waitcnt vmcnt(0)
    v_cmp_ne_u64 vcc, s[62:63], v[236:237]
    s_sub_u32 s3, s3, 1
    s_cmp_eq_u32 s3, 0
    s_cbranch_scc1 L_ok_25
    s_nop 2
    s_cbranch_vccnz L_spin_26
L_ok_25:
    s_and_b32 s4, s78, 15
    s_lshr_b64 s[78:79], s[78:79], 4
    s_lshl_b32 s4, s4, 12
    s_add_u32 s4, s4, s58
    buffer_load_dwordx4 v[128:131], v30, s[16:19], s4 offen offset:0 sc1
    buffer_load_dwordx4 v[132:135], v31, s[16:19], s4 offen offset:0 sc1
    buffer_load_dwordx4 v[136:139], v30, s[16:19], s4 offen offset:2048 sc1
    buffer_load_dwordx4 v[140:143], v31, s[16:19], s4 offen offset:2048 sc1
    s_and_b32 s4, s78, 15
    s_lshr_b64 s[78:79], s[78:79], 4
    s_lshl_b32 s4, s4, 12
    s_add_u32 s4, s4, s58
    buffer_load_dwordx4 v[144:147], v30, s[16:19], s4 offen offset:0 sc1
    buffer_load_dwordx4 v[148:151], v31, s[16:19], s4 offen offset:0 sc1
    buffer_load_dwordx4 v[152:155], v30, s[16:19], s4 offen offset:2048 sc1
    buffer_load_dwordx4 v[156:159], v31, s[16:19], s4 offen offset:2048 sc1
    s_and_b32 s4, s78, 15
    s_lshr_b64 s[78:79], s[78:79], 4
    s_lshl_b32 s4, s4, 12
    s_add_u32 s4, s4, s58
    buffer_load_dwordx4 v[160:163], v30, s[16:19], s4 offen offset:0 sc1
    buffer_load_dwordx4 v[164:167], v31, s[16:19], s4 offen offset:0 sc1
    buffer_load_dwordx4 v[168:171], v30, s[16:19], s4 offen offset:2048 sc1
    buffer_load_dwordx4 v[172:175], v31, s[16:19], s4 offen offset:2048 sc1
    s_lshl_b32 s3, s31, 10
    s_lshl_b32 s7, s24, 8
    s_add_u32 s3, s3, s7
    s_add_u32 s3, s3, 655360
    v_and_b32 v6, 1, v1
    v_lshl_add_u32 v238, v6, 7, s3
    s_waitcnt vmcnt(12)
    v_mfma_f32_32x32x16_bf16 v[64:79], v[32:35], v[48:51], 0
    v_mfma_f32_32x32x16_bf16 v[64:79], v[36:39], v[52:55], v[64:79]
    v_mfma_f32_32x32x16_bf16 v[80:95], v[40:43], v[56:59], 0
    v_mfma_f32_32x32x16_bf16 v[80:95], v[44:47], v[60:63], v[80:95]
    s_nop 9
    v_add_f32 v72, 0x358637bd, v72
    v_rcp_f32 v72, v72
    s_nop 0
    v_mul_f32 v72, v208, v72
    v_pk_mul_f32 v[64:65], v[64:65], v[72:73] op_sel:[0,0] op_sel_hi:[1,0]
    v_pk_mul_f32 v[66:67], v[66:67], v[72:73] op_sel:[0,0] op_sel_hi:[1,0]
    v_pk_mul_f32 v[68:69], v[68:69], v[72:73] op_sel:[0,0] op_sel_hi:[1,0]
    v_pk_mul_f32 v[70:71], v[70:71], v[72:73] op_sel:[0,0] op_sel_hi:[1,0]
    v_cvt_pk_bf16_f32 v216, v64, v65
    v_cvt_pk_bf16_f32 v217, v66, v67
    v_cvt_pk_bf16_f32 v218, v68, v69
    v_cvt_pk_bf16_f32 v219, v70, v71
    buffer_store_dwordx4 v[216:219], v5, s[16:19], s76 offen offset:0 sc1
    v_add_f32 v88, 0x358637bd, v88
    v_rcp_f32 v88, v88
    s_nop 0
    v_mul_f32 v88, v208, v88
    v_pk_mul_f32 v[80:81], v[80:81], v[88:89] op_sel:[0,0] op_sel_hi:[1,0]
    v_pk_mul_f32 v[82:83], v[82:83], v[88:89] op_sel:[0,0] op_sel_hi:[1,0]
    v_pk_mul_f32 v[84:85], v[84:85], v[88:89] op_sel:[0,0] op_sel_hi:[1,0]
    v_pk_mul_f32 v[86:87], v[86:87], v[88:89] op_sel:[0,0] op_sel_hi:[1,0]
    v_cvt_pk_bf16_f32 v220, v80, v81
    v_cvt_pk_bf16_f32 v221, v82, v83
    v_cvt_pk_bf16_f32 v222, v84, v85
    v_cvt_pk_bf16_f32 v223, v86, v87
    buffer_store_dwordx4 v[220:223], v5, s[16:19], s76 offen offset:2048 sc1
    s_waitcnt vmcnt(10)
    v_mfma_f32_32x32x16_bf16 v[64:79], v[128:131], a[0:3], 0
    s_and_b32 s4, s73, 15
    s_lshr_b32 s73, s73, 4
    s_add_u32 m0, s75, 69632
    s_lshl_b32 s4, s4, 15
    s_add_u32 s4, s4, s33
    buffer_load_dwordx4 v10, s[12:15], s4 offen offset:0 lds
    buffer_load_dwordx4 v11, s[12:15], s4 offen offset:1024 lds
    v_mfma_f32_32x32x16_bf16 v[80:95], v[128:131], a[4:7], 0
    buffer_load_dwordx4 v12, s[12:15], s4 offen offset:2048 lds
    v_mfma_f32_32x32x16_bf16 v[96:111], v[132:135], a[0:3], 0
    buffer_load_dwordx4 v13, s[12:15], s4 offen offset:3072 lds
    v_mfma_f32_32x32x16_bf16 v[112:127], v[132:135], a[4:7], 0
    s_and_b32 s4, s78, 15
    s_lshr_b64 s[78:79], s[78:79], 4
    s_lshl_b32 s4, s4, 12
    s_add_u32 s4, s4, s58
    buffer_load_dwordx4 v[176:179], v30, s[16:19], s4 offen offset:0 sc1
    v_mfma_f32_32x32x16_bf16 v[64:79], v[136:139], a[8:11], v[64:79]
    buffer_load_dwordx4 v[180:183], v31, s[16:19], s4 offen offset:0 sc1
    buffer_load_dwordx4 v[184:187], v30, s[16:19], s4 offen offset:2048 sc1
    v_mfma_f32_32x32x16_bf16 v[80:95], v[136:139], a[12:15], v[80:95]
    buffer_load_dwordx4 v[188:191], v31, s[16:19], s4 offen offset:2048 sc1
    v_mfma_f32_32x32x16_bf16 v[96:111], v[140:143], a[8:11], v[96:111]
    ds_read_b64_tr_b16 a[176:177], v28 offset:0
    ds_read_b64_tr_b16 a[178:179], v28 offset:1024
    ds_read_b64_tr_b16 a[180:181], v29 offset:0
    ds_read_b64_tr_b16 a[182:183], v29 offset:1024
    v_mfma_f32_32x32x16_bf16 v[112:127], v[140:143], a[12:15], v[112:127]
    ds_read_b64_tr_b16 a[184:185], v28 offset:2048
    ds_read_b64_tr_b16 a[186:187], v28 offset:3072
    ds_read_b64_tr_b16 a[188:189], v29 offset:2048
    ds_read_b64_tr_b16 a[190:191], v29 offset:3072
    s_waitcnt vmcnt(14)
    v_mfma_f32_32x32x16_bf16 v[64:79], v[144:147], a[16:19], v[64:79]
    s_waitcnt lgkmcnt(15)
    s_and_b32 s4, s73, 15
    s_lshr_b32 s73, s73, 4
    s_add_u32 m0, s75, 36864
    s_lshl_b32 s4, s4, 15
    s_add_u32 s4, s4, s33
    buffer_load_dwordx4 v10, s[12:15], s4 offen offset:0 lds
    buffer_load_dwordx4 v11, s[12:15], s4 offen offset:1024 lds
    v_mfma_f32_32x32x16_bf16 v[80:95], v[144:147], a[20:23], v[80:95]
    buffer_load_dwordx4 v12, s[12:15], s4 offen offset:2048 lds
    v_mfma_f32_32x32x16_bf16 v[96:111], v[148:151], a[16:19], v[96:111]
    buffer_load_dwordx4 v13, s[12:15], s4 offen offset:3072 lds
    v_mfma_f32_32x32x16_bf16 v[112:127], v[148:151], a[20:23], v[112:127]
    s_and_b32 s4, s78, 15
    s_lshr_b64 s[78:79], s[78:79], 4
    s_lshl_b32 s4, s4, 12
    s_add_u32 s4, s4, s58
    buffer_load_dwordx4 v[192:195], v30, s[16:19], s4 offen offset:0 sc1
    v_mfma_f32_32x32x16_bf16 v[64:79], v[152:155], a[24:27], v[64:79]
    buffer_load_dwordx4 v[196:199], v31, s[16:19], s4 offen offset:0 sc1
    buffer_load_dwordx4 v[200:203], v30, s[16:19], s4 offen offset:2048 sc1
    v_mfma_f32_32x32x16_bf16 v[80:95], v[152:155], a[28:31], v[80:95]
    buffer_load_dwordx4 v[204:207], v31, s[16:19], s4 offen offset:2048 sc1
    v_mfma_f32_32x32x16_bf16 v[96:111], v[156:159], a[24:27], v[96:111]
    ds_read_b64_tr_b16 a[192:193], v28 offset:4096
    ds_read_b64_tr_b16 a[194:195], v28 offset:5120
    ds_read_b64_tr_b16 a[196:197], v29 offset:4096
    ds_read_b64_tr_b16 a[198:199], v29 offset:5120
    v_mfma_f32_32x32x16_bf16 v[112:127], v[156:159], a[28:31], v[112:127]
    ds_read_b64_tr_b16 a[200:201], v28 offset:6144
    ds_read_b64_tr_b16 a[202:203], v28 offset:7168
    ds_read_b64_tr_b16 a[204:205], v29 offset:6144
    ds_read_b64_tr_b16 a[206:207], v29 offset:7168
    s_waitcnt vmcnt(16)
    s_barrier
    s_cmp_lg_u32 s24, 0
    s_cbranch_scc1 L_nf_27
    v_mov_b32 v2, s62
    v_mov_b32 v3, s63
    v_mov_b32 v4, 0
    s_mov_b64 exec, 1
    buffer_store_dwordx2 v[2:3], v4, s[16:19], s77 offen sc1
    s_mov_b64 exec, -1
L_nf_27:
    s_nop 3
    v_mfma_f32_32x32x16_bf16 v[64:79], v[160:163], a[32:35], v[64:79]
    s_waitcnt lgkmcnt(15)
    s_and_b32 s4, s73, 15
    s_lshr_b32 s73, s73, 4
    s_add_u32 m0, s75, 98304
    s_lshl_b32 s4, s4, 15
    s_add_u32 s4, s4, s33
    buffer_load_dwordx4 v10, s[12:15], s4 offen offset:0 lds
    buffer_load_dwordx4 v11, s[12:15], s4 offen offset:1024 lds
    v_mfma_f32_32x32x16_bf16 v[80:95], v[160:163], a[36:39], v[80:95]
    buffer_load_dwordx4 v12, s[12:15], s4 offen offset:2048 lds
    v_mfma_f32_32x32x16_bf16 v[96:111], v[164:167], a[32:35], v[96:111]
    buffer_load_dwordx4 v13, s[12:15], s4 offen offset:3072 lds
    v_mfma_f32_32x32x16_bf16 v[112:127], v[164:167], a[36:39], v[112:127]
    s_and_b32 s4, s78, 15
    s_lshr_b64 s[78:79], s[78:79], 4
    s_lshl_b32 s4, s4, 12
    s_add_u32 s4, s4, s58
    buffer_load_dwordx4 v[128:131], v30, s[16:19], s4 offen offset:0 sc1
    v_mfma_f32_32x32x16_bf16 v[64:79], v[168:171], a[40:43], v[64:79]
    buffer_load_dwordx4 v[132:135], v31, s[16:19], s4 offen offset:0 sc1
    buffer_load_dwordx4 v[136:139], v30, s[16:19], s4 offen offset:2048 sc1
    v_mfma_f32_32x32x16_bf16 v[80:95], v[168:171], a[44:47], v[80:95]
    buffer_load_dwordx4 v[140:143], v31, s[16:19], s4 offen offset:2048 sc1
    v_mfma_f32_32x32x16_bf16 v[96:111], v[172:175], a[40:43], v[96:111]
    ds_read_b64_tr_b16 a[208:209], v26 offset:0
    ds_read_b64_tr_b16 a[210:211], v26 offset:1024
    ds_read_b64_tr_b16 a[212:213], v27 offset:0
    ds_read_b64_tr_b16 a[214:215], v27 offset:1024
    v_mfma_f32_32x32x16_bf16 v[112:127], v[172:175], a[44:47], v[112:127]
    ds_read_b64_tr_b16 a[216:217], v26 offset:2048
    ds_read_b64_tr_b16 a[218:219], v26 offset:3072
    ds_read_b64_tr_b16 a[220:221], v27 offset:2048
    ds_read_b64_tr_b16 a[222:223], v27 offset:3072
    s_waitcnt vmcnt(16)
    v_mfma_f32_32x32x16_bf16 v[64:79], v[176:179], a[48:51], v[64:79]
    s_and_b32 s4, s78, 15
    s_lshr_b64 s[78:79], s[78:79], 4
    s_lshl_b32 s4, s4, 12
    s_add_u32 s4, s4, s58
    buffer_load_dwordx4 v[144:147], v30, s[16:19], s4 offen offset:0 sc1
    v_mfma_f32_32x32x16_bf16 v[80:95], v[176:179], a[52:55], v[80:95]
    v_mfma_f32_32x32x16_bf16 v[96:111], v[180:183], a[48:51], v[96:111]
    buffer_load_dwordx4 v[148:151], v31, s[16:19], s4 offen offset:0 sc1
    v_mfma_f32_32x32x16_bf16 v[112:127], v[180:183], a[52:55], v[112:127]
    v_mfma_f32_32x32x16_bf16 v[64:79], v[184:187], a[56:59], v[64:79]
    buffer_load_dwordx4 v[152:155], v30, s[16:19], s4 offen offset:2048 sc1
    v_mfma_f32_32x32x16_bf16 v[80:95], v[184:187], a[60:63], v[80:95]
    v_mfma_f32_32x32x16_bf16 v[96:111], v[188:191], a[56:59], v[96:111]
    buffer_load_dwordx4 v[156:159], v31, s[16:19], s4 offen offset:2048 sc1
    v_mfma_f32_32x32x16_bf16 v[112:127], v[188:191], a[60:63], v[112:127]
    s_waitcnt vmcnt(12)
    v_mfma_f32_32x32x16_bf16 v[64:79], v[192:195], a[64:67], v[64:79]
    s_and_b32 s4, s78, 15
    s_lshr_b64 s[78:79], s[78:79], 4
    s_lshl_b32 s4, s4, 12
    s_add_u32 s4, s4, s58
    buffer_load_dwordx4 v[160:163], v30, s[16:19], s4 offen offset:0 sc1
    v_mfma_f32_32x32x16_bf16 v[80:95], v[192:195], a[68:71], v[80:95]
    v_mfma_f32_32x32x16_bf16 v[96:111], v[196:199], a[64:67], v[96:111]
    buffer_load_dwordx4 v[164:167], v31, s[16:19], s4 offen offset:0 sc1
    v_mfma_f32_32x32x16_bf16 v[112:127], v[196:199], a[68:71], v[112:127]
    v_mfma_f32_32x32x16_bf16 v[64:79], v[200:203], a[72:75], v[64:79]
    buffer_load_dwordx4 v[168:171], v30, s[16:19], s4 offen offset:2048 sc1
    v_mfma_f32_32x32x16_bf16 v[80:95], v[200:203], a[76:79], v[80:95]
    v_mfma_f32_32x32x16_bf16 v[96:111], v[204:207], a[72:75], v[96:111]
    buffer_load_dwordx4 v[172:175], v31, s[16:19], s4 offen offset:2048 sc1
    v_mfma_f32_32x32x16_bf16 v[112:127], v[204:207], a[76:79], v[112:127]
    s_waitcnt vmcnt(8)
    v_mfma_f32_32x32x16_bf16 v[64:79], v[128:131], a[80:83], v[64:79]
    s_and_b32 s4, s78, 15
    s_lshr_b64 s[78:79], s[78:79], 4
    s_lshl_b32 s4, s4, 12
    s_add_u32 s4, s4, s58
    buffer_load_dwordx4 v[176:179], v30, s[16:19], s4 offen offset:0 sc1
    v_mfma_f32_32x32x16_bf16 v[80:95], v[128:131], a[84:87], v[80:95]
    v_mfma_f32_32x32x16_bf16 v[96:111], v[132:135], a[80:83], v[96:111]
    buffer_load_dwordx4 v[180:183], v31, s[16:19], s4 offen offset:0 sc1
    v_mfma_f32_32x32x16_bf16 v[112:127], v[132:135], a[84:87], v[112:127]
    v_mfma_f32_32x32x16_bf16 v[64:79], v[136:139], a[88:91], v[64:79]
    buffer_load_dwordx4 v[184:187], v30, s[16:19], s4 offen offset:2048 sc1
    v_mfma_f32_32x32x16_bf16 v[80:95], v[136:139], a[92:95], v[80:95]
    v_mfma_f32_32x32x16_bf16 v[96:111], v[140:143], a[88:91], v[96:111]
    buffer_load_dwordx4 v[188:191], v31, s[16:19], s4 offen offset:2048 sc1
    v_mfma_f32_32x32x16_bf16 v[112:127], v[140:143], a[92:95], v[112:127]
    s_waitcnt vmcnt(8)
    v_mfma_f32_32x32x16_bf16 v[64:79], v[144:147], a[96:99], v[64:79]
    s_and_b32 s4, s78, 15
    s_lshr_b64 s[78:79], s[78:79], 4
    s_lshl_b32 s4, s4, 12
    s_add_u32 s4, s4, s58
    buffer_load_dwordx4 v[192:195], v30, s[16:19], s4 offen offset:0 sc1
    v_mfma_f32_32x32x16_bf16 v[80:95], v[144:147], a[100:103], v[80:95]
    v_mfma_f32_32x32x16_bf16 v[96:111], v[148:151], a[96:99], v[96:111]
    buffer_load_dwordx4 v[196:199], v31, s[16:19], s4 offen offset:0 sc1
    v_mfma_f32_32x32x16_bf16 v[112:127], v[148:151], a[100:103], v[112:127]
    v_mfma_f32_32x32x16_bf16 v[64:79], v[152:155], a[104:107], v[64:79]
    buffer_load_dwordx4 v[200:203], v30, s[16:19], s4 offen offset:2048 sc1
    v_mfma_f32_32x32x16_bf16 v[80:95], v[152:155], a[108:111], v[80:95]
    v_mfma_f32_32x32x16_bf16 v[96:111], v[156:159], a[104:107], v[96:111]
    buffer_load_dwordx4 v[204:207], v31, s[16:19], s4 offen offset:2048 sc1
    v_mfma_f32_32x32x16_bf16 v[112:127], v[156:159], a[108:111], v[112:127]
    s_waitcnt vmcnt(8)
    v_mfma_f32_32x32x16_bf16 v[64:79], v[160:163], a[112:115], v[64:79]
    s_and_b32 s4, s78, 15
    s_lshr_b64 s[78:79], s[78:79], 4
    s_lshl_b32 s4, s4, 12
    s_add_u32 s4, s4, s58
    buffer_load_dwordx4 v[128:131], v30, s[16:19], s4 offen offset:0 sc1
    v_mfma_f32_32x32x16_bf16 v[80:95], v[160:163], a[116:119], v[80:95]
    v_mfma_f32_32x32x16_bf16 v[96:111], v[164:167], a[112:115], v[96:111]
    buffer_load_dwordx4 v[132:135], v31, s[16:19], s4 offen offset:0 sc1
    v_mfma_f32_32x32x16_bf16 v[112:127], v[164:167], a[116:119], v[112:127]
    v_mfma_f32_32x32x16_bf16 v[64:79], v[168:171], a[120:123], v[64:79]
    buffer_load_dwordx4 v[136:139], v30, s[16:19], s4 offen offset:2048 sc1
    v_mfma_f32_32x32x16_bf16 v[80:95], v[168:171], a[124:127], v[80:95]
    v_mfma_f32_32x32x16_bf16 v[96:111], v[172:175], a[120:123], v[96:111]
    buffer_load_dwordx4 v[140:143], v31, s[16:19], s4 offen offset:2048 sc1
    v_mfma_f32_32x32x16_bf16 v[112:127], v[172:175], a[124:127], v[112:127]
    s_waitcnt vmcnt(8)
    v_mfma_f32_32x32x16_bf16 v[64:79], v[176:179], a[128:131], v[64:79]
    s_and_b32 s4, s78, 15
    s_lshr_b64 s[78:79], s[78:79], 4
    s_lshl_b32 s4, s4, 12
    s_add_u32 s4, s4, s58
    buffer_load_dwordx4 v[144:147], v30, s[16:19], s4 offen offset:0 sc1
    v_mfma_f32_32x32x16_bf16 v[80:95], v[176:179], a[132:135], v[80:95]
    v_mfma_f32_32x32x16_bf16 v[96:111], v[180:183], a[128:131], v[96:111]
    buffer_load_dwordx4 v[148:151], v31, s[16:19], s4 offen offset:0 sc1
    v_mfma_f32_32x32x16_bf16 v[112:127], v[180:183], a[132:135], v[112:127]
    v_sub_f32 v14, 1.0, v210
    v_sub_f32 v15, 1.0, v211
    v_lshlrev_b32 v16, 16, v209
    v_mul_f32 v16, v14, v16
    s_lshl_b32 s3, s31, 16
    s_and_b32 s7, s24, 1
    s_lshl_b32 s7, s7, 15
    s_add_u32 s3, s3, s7
    s_lshl_b32 s7, s27, 7
    s_add_u32 s3, s3, s7
    s_lshr_b32 s7, s24, 1
    s_lshl_b32 s7, s7, 6
    s_add_u32 s76, s3, s7
    v_and_b32 v6, 31, v1
    v_lshlrev_b32 v6, 10, v6
    v_lshl_add_u32 v17, v9, 4, v6
    buffer_load_dwordx2 v[236:237], v238, s[16:19], 0 offen sc1
    v_mfma_f32_32x32x16_bf16 v[64:79], v[184:187], a[136:139], v[64:79]
    buffer_load_dwordx4 v[152:155], v30, s[16:19], s4 offen offset:2048 sc1
    v_mfma_f32_32x32x16_bf16 v[80:95], v[184:187], a[140:143], v[80:95]
    v_mfma_f32_32x32x16_bf16 v[96:111], v[188:191], a[136:139], v[96:111]
    buffer_load_dwordx4 v[156:159], v31, s[16:19], s4 offen offset:2048 sc1
    v_mfma_f32_32x32x16_bf16 v[112:127], v[188:191], a[140:143], v[112:127]
    s_waitcnt vmcnt(9)
    v_mfma_f32_32x32x16_bf16 v[64:79], v[192:195], a[144:147], v[64:79]
    ds_read_b64_tr_b16 a[0:1], v228 offset:36864
    s_and_b32 s4, s78, 15
    s_lshr_b64 s[78:79], s[78:79], 4
    s_lshl_b32 s4, s4, 12
    s_add_u32 s4, s4, s58
    buffer_load_dwordx4 v[160:163], v30, s[16:19], s4 offen offset:0 sc1
    v_mfma_f32_32x32x16_bf16 v[80:95], v[192:195], a[148:151], v[80:95]
    ds_read_b64_tr_b16 a[2:3], v228 offset:37888
    v_mfma_f32_32x32x16_bf16 v[96:111], v[196:199], a[144:147], v[96:111]
    ds_read_b64_tr_b16 a[4:5], v229 offset:36864
    buffer_load_dwordx4 v[164:167], v31, s[16:19], s4 offen offset:0 sc1
    v_mfma_f32_32x32x16_bf16 v[112:127], v[196:199], a[148:151], v[112:127]
    ds_read_b64_tr_b16 a[6:7], v229 offset:37888
    v_mfma_f32_32x32x16_bf16 v[64:79], v[200:203], a[152:155], v[64:79]
    ds_read_b64_tr_b16 a[8:9], v228 offset:38912
    buffer_load_dwordx4 v[168:171], v30, s[16:19], s4 offen offset:2048 sc1
    v_mfma_f32_32x32x16_bf16 v[80:95], v[200:203], a[156:159], v[80:95]
    ds_read_b64_tr_b16 a[10:11], v228 offset:39936
    v_mfma_f32_32x32x16_bf16 v[96:111], v[204:207], a[152:155], v[96:111]
    ds_read_b64_tr_b16 a[12:13], v229 offset:38912
    buffer_load_dwordx4 v[172:175], v31, s[16:19], s4 offen offset:2048 sc1
    v_mfma_f32_32x32x16_bf16 v[112:127], v[204:207], a[156:159], v[112:127]
    ds_read_b64_tr_b16 a[14:15], v229 offset:39936
    s_waitcnt vmcnt(9)
    v_mfma_f32_32x32x16_bf16 v[64:79], v[128:131], a[160:163], v[64:79]
    ds_read_b64_tr_b16 a[16:17], v228 offset:4096
    s_and_b32 s4, s78, 15
    s_lshr_b64 s[78:79], s[78:79], 4
    s_lshl_b32 s4, s4, 12
    s_add_u32 s4, s4, s58
    buffer_load_dwordx4 v[176:179], v30, s[16:19], s4 offen offset:0 sc1
    v_mfma_f32_32x32x16_bf16 v[80:95], v[128:131], a[164:167], v[80:95]
    ds_read_b64_tr_b16 a[18:19], v228 offset:5120
    v_mfma_f32_32x32x16_bf16 v[96:111], v[132:135], a[160:163], v[96:111]
    ds_read_b64_tr_b16 a[20:21], v229 offset:4096
    buffer_load_dwordx4 v[180:183], v31, s[16:19], s4 offen offset:0 sc1
    v_mfma_f32_32x32x16_bf16 v[112:127], v[132:135], a[164:167], v[112:127]
    ds_read_b64_tr_b16 a[22:23], v229 offset:5120
    v_mfma_f32_32x32x16_bf16 v[64:79], v[136:139], a[168:171], v[64:79]
    ds_read_b64_tr_b16 a[24:25], v228 offset:6144
    buffer_load_dwordx4 v[184:187], v30, s[16:19], s4 offen offset:2048 sc1
    v_mfma_f32_32x32x16_bf16 v[80:95], v[136:139], a[172:175], v[80:95]
    ds_read_b64_tr_b16 a[26:27], v228 offset:7168
    v_mfma_f32_32x32x16_bf16 v[96:111], v[140:143], a[168:171], v[96:111]
    ds_read_b64_tr_b16 a[28:29], v229 offset:6144
    buffer_load_dwordx4 v[188:191], v31, s[16:19], s4 offen offset:2048 sc1
    v_mfma_f32_32x32x16_bf16 v[112:127], v[140:143], a[172:175], v[112:127]
    ds_read_b64_tr_b16 a[30:31], v229 offset:7168
    s_waitcnt vmcnt(8) lgkmcnt(15)
    v_cmp_ne_u64 vcc, s[62:63], v[236:237]
    s_nop 4
    s_cbranch_vccz L_ok_28
    s_mov_b32 s3, 50000
L_spin_29:
    s_sleep 2
    buffer_load_dwordx2 v[236:237], v238, s[16:19], 0 offen sc1
    s_waitcnt vmcnt(0)
    v_cmp_ne_u64 vcc, s[62:63], v[236:237]
    s_sub_u32 s3, s3, 1
    s_cmp_eq_u32 s3, 0
    s_cbranch_scc1 L_ok_28
    s_nop 2
    s_cbranch_vccnz L_spin_29
L_ok_28:
    v_mfma_f32_32x32x16_bf16 v[64:79], v[144:147], a[176:179], v[64:79]
    ds_read_b64_tr_b16 a[32:33], v226 offset:36864
    s_and_b32 s4, s35, 15
    s_lshr_b32 s35, s35, 4
    s_lshl_b32 s4, s4, 12
    s_add_u32 s4, s4, s59
    buffer_load_dwordx4 v[192:195], v22, s[16:19], s4 offen offset:0 sc1
    v_mfma_f32_32x32x16_bf16 v[80:95], v[144:147], a[180:183], v[80:95]
    ds_read_b64_tr_b16 a[34:35], v226 offset:37888
    buffer_load_dwordx4 v[196:199], v23, s[16:19], s4 offen offset:0 sc1
    v_mfma_f32_32x32x16_bf16 v[96:111], v[148:151], a[176:179], v[96:111]
    ds_read_b64_tr_b16 a[36:37], v227 offset:36864
    buffer_load_dwordx4 v[200:203], v22, s[16:19], s4 offen offset:2048 sc1
    v_mfma_f32_32x32x16_bf16 v[112:127], v[148:151], a[180:183], v[112:127]
    ds_read_b64_tr_b16 a[38:39], v227 offset:37888
    buffer_load_dwordx4 v[204:207], v23, s[16:19], s4 offen offset:2048 sc1
    v_mfma_f32_32x32x16_bf16 v[64:79], v[152:155], a[184:187], v[64:79]
    ds_read_b64_tr_b16 a[40:41], v226 offset:38912
    s_and_b32 s4, s35, 15
    s_lshr_b32 s35, s35, 4
    s_lshl_b32 s4, s4, 12
    s_add_u32 s4, s4, s59
    buffer_load_dwordx4 v[128:131], v22, s[16:19], s4 offen offset:0 sc1
    v_mfma_f32_32x32x16_bf16 v[80:95], v[152:155], a[188:191], v[80:95]
    ds_read_b64_tr_b16 a[42:43], v226 offset:39936
    buffer_load_dwordx4 v[132:135], v23, s[16:19], s4 offen offset:0 sc1
    v_mfma_f32_32x32x16_bf16 v[96:111], v[156:159], a[184:187], v[96:111]
    ds_read_b64_tr_b16 a[44:45], v227 offset:38912
    buffer_load_dwordx4 v[136:139], v22, s[16:19], s4 offen offset:2048 sc1
    v_mfma_f32_32x32x16_bf16 v[112:127], v[156:159], a[188:191], v[112:127]
    ds_read_b64_tr_b16 a[46:47], v227 offset:39936
    buffer_load_dwordx4 v[140:143], v23, s[16:19], s4 offen offset:2048 sc1
    s_waitcnt vmcnt(12)
    v_mfma_f32_32x32x16_bf16 v[64:79], v[160:163], a[192:195], v[64:79]
    ds_read_b64_tr_b16 a[48:49], v228 offset:32768
    s_and_b32 s4, s35, 15
    s_lshr_b32 s35, s35, 4
    s_lshl_b32 s4, s4, 12
    s_add_u32 s4, s4, s59
    buffer_load_dwordx4 v[32:35], v22, s[16:19], s4 offen offset:0 sc1
    v_mfma_f32_32x32x16_bf16 v[80:95], v[160:163], a[196:199], v[80:95]
    ds_read_b64_tr_b16 a[50:51], v228 offset:33792
    buffer_load_dwordx4 v[36:39], v23, s[16:19], s4 offen offset:0 sc1
    v_mfma_f32_32x32x16_bf16 v[96:111], v[164:167], a[192:195], v[96:111]
    ds_read_b64_tr_b16 a[52:53], v229 offset:32768
    buffer_load_dwordx4 v[40:43], v22, s[16:19], s4 offen offset:2048 sc1
    v_mfma_f32_32x32x16_bf16 v[112:127], v[164:167], a[196:199], v[112:127]
    ds_read_b64_tr_b16 a[54:55], v229 offset:33792
    buffer_load_dwordx4 v[44:47], v23, s[16:19], s4 offen offset:2048 sc1
    v_mfma_f32_32x32x16_bf16 v[64:79], v[168:171], a[200:203], v[64:79]
    ds_read_b64_tr_b16 a[56:57], v228 offset:34816
    s_and_b32 s4, s35, 15
    s_lshr_b32 s35, s35, 4
    s_lshl_b32 s4, s4, 12
    s_add_u32 s4, s4, s59
    buffer_load_dwordx4 v[48:51], v22, s[16:19], s4 offen offset:0 sc1
    v_mfma_f32_32x32x16_bf16 v[80:95], v[168:171], a[204:207], v[80:95]
    ds_read_b64_tr_b16 a[58:59], v228 offset:35840
    buffer_load_dwordx4 v[52:55], v23, s[16:19], s4 offen offset:0 sc1
    v_mfma_f32_32x32x16_bf16 v[96:111], v[172:175], a[200:203], v[96:111]
    ds_read_b64_tr_b16 a[60:61], v229 offset:34816
    buffer_load_dwordx4 v[56:59], v22, s[16:19], s4 offen offset:2048 sc1
    v_mfma_f32_32x32x16_bf16 v[112:127], v[172:175], a[204:207], v[112:127]
    ds_read_b64_tr_b16 a[62:63], v229 offset:35840
    buffer_load_dwordx4 v[60:63], v23, s[16:19], s4 offen offset:2048 sc1
    s_waitcnt vmcnt(16)
    v_mfma_f32_32x32x16_bf16 v[64:79], v[176:179], a[208:211], v[64:79]
    v_mfma_f32_32x32x16_bf16 v[80:95], v[176:179], a[212:215], v[80:95]
    v_mfma_f32_32x32x16_bf16 v[96:111], v[180:183], a[208:211], v[96:111]
    v_mfma_f32_32x32x16_bf16 v[112:127], v[180:183], a[212:215], v[112:127]
    s_barrier
    v_mfma_f32_32x32x16_bf16 v[80:95], v[184:187], a[220:223], v[80:95]
    v_mfma_f32_32x32x16_bf16 v[96:111], v[188:191], a[216:219], v[96:111]
    v_mfma_f32_32x32x16_bf16 v[112:127], v[188:191], a[220:223], v[112:127]
    v_mfma_f32_32x32x16_bf16 v[64:79], v[184:187], a[216:219], v[64:79]
    s_nop 8
    v_mul_f32 v80, v15, v80
    v_mul_f32 v81, v15, v81
    v_mul_f32 v82, v15, v82
    v_mul_f32 v83, v15, v83
    v_mul_f32 v84, v15, v84
    v_mul_f32 v85, v15, v85
    v_mul_f32 v86, v15, v86
    v_mul_f32 v87, v15, v87
    v_mul_f32 v88, v15, v88
    v_mul_f32 v89, v15, v89
    v_mul_f32 v90, v15, v90
    v_mul_f32 v91, v15, v91
    v_mul_f32 v92, v15, v92
    v_mul_f32 v93, v15, v93
    v_mul_f32 v94, v15, v94
    v_mul_f32 v95, v15, v95
    s_waitcnt lgkmcnt(0)
    s_waitcnt vmcnt(12)
    v_mfma_f32_32x32x16_bf16 v[80:95], a[0:3], v[196:199], v[80:95]
    v_mul_f32 v96, v14, v96
    v_mul_f32 v97, v14, v97
    v_mul_f32 v98, v14, v98
    v_mul_f32 v99, v14, v99
    v_mfma_f32_32x32x16_bf16 v[80:95], a[8:11], v[204:207], v[80:95]
    v_mul_f32 v100, v14, v100
    v_mul_f32 v101, v14, v101
    v_mul_f32 v102, v14, v102
    v_mul_f32 v103, v14, v103
    s_waitcnt vmcnt(8)
    v_mfma_f32_32x32x16_bf16 v[80:95], a[16:19], v[132:135], v[80:95]
    v_mul_f32 v104, v14, v104
    v_mul_f32 v105, v14, v105
    v_mul_f32 v106, v14, v106
    v_mul_f32 v107, v14, v107
    v_mfma_f32_32x32x16_bf16 v[80:95], a[24:27], v[140:143], v[80:95]
    v_mul_f32 v108, v14, v108
    v_mul_f32 v109, v14, v109
    v_mul_f32 v110, v14, v110
    v_mul_f32 v111, v14, v111
    s_waitcnt vmcnt(4)
    v_mfma_f32_32x32x16_bf16 v[80:95], a[32:35], v[36:39], v[80:95]
    v_mfma_f32_32x32x16_bf16 v[80:95], a[40:43], v[44:47], v[80:95]
    s_waitcnt vmcnt(0)
    v_mfma_f32_32x32x16_bf16 v[80:95], a[48:51], v[52:55], v[80:95]
    v_mfma_f32_32x32x16_bf16 v[80:95], a[56:59], v[60:63], v[80:95]
    v_mfma_f32_32x32x16_bf16 v[96:111], a[4:7], v[192:195], v[96:111]
    v_mul_f32 v112, v15, v112
    v_mul_f32 v113, v15, v113
    v_mul_f32 v114, v15, v114
    v_mul_f32 v115, v15, v115
    v_mfma_f32_32x32x16_bf16 v[96:111], a[12:15], v[200:203], v[96:111]
    v_mul_f32 v116, v15, v116
    v_mul_f32 v117, v15, v117
    v_mul_f32 v118, v15, v118
    v_mul_f32 v119, v15, v119
    v_mfma_f32_32x32x16_bf16 v[96:111], a[20:23], v[128:131], v[96:111]
    v_mul_f32 v120, v15, v120
    v_mul_f32 v121, v15, v121
    v_mul_f32 v122, v15, v122
    v_mul_f32 v123, v15, v123
    v_mfma_f32_32x32x16_bf16 v[96:111], a[28:31], v[136:139], v[96:111]
    v_mul_f32 v124, v15, v124
    v_mul_f32 v125, v15, v125
    v_mul_f32 v126, v15, v126
    v_mul_f32 v127, v15, v127
    v_mfma_f32_32x32x16_bf16 v[96:111], a[36:39], v[32:35], v[96:111]
    ds_write_b128 v234, v[80:83] offset:0
    v_mfma_f32_32x32x16_bf16 v[96:111], a[44:47], v[40:43], v[96:111]
    ds_write_b128 v234, v[84:87] offset:1024
    v_mfma_f32_32x32x16_bf16 v[96:111], a[52:55], v[48:51], v[96:111]
    ds_write_b128 v234, v[88:91] offset:2048
    v_mfma_f32_32x32x16_bf16 v[96:111], a[60:63], v[56:59], v[96:111]
    ds_write_b128 v234, v[92:95] offset:3072
    v_mfma_f32_32x32x16_bf16 v[112:127], a[4:7], v[196:199], v[112:127]
    v_fma_f32 v64, v64, v14, v16
    v_fma_f32 v65, v65, v14, v16
    v_fma_f32 v66, v66, v14, v16
    v_fma_f32 v67, v67, v14, v16
    v_mfma_f32_32x32x16_bf16 v[112:127], a[12:15], v[204:207], v[112:127]
    v_fma_f32 v68, v68, v14, v16
    v_fma_f32 v69, v69, v14, v16
    v_fma_f32 v70, v70, v14, v16
    v_fma_f32 v71, v71, v14, v16
    v_mfma_f32_32x32x16_bf16 v[112:127], a[20:23], v[132:135], v[112:127]
    v_fma_f32 v72, v72, v14, v16
    v_fma_f32 v73, v73, v14, v16
    v_fma_f32 v74, v74, v14, v16
    v_fma_f32 v75, v75, v14, v16
    v_mfma_f32_32x32x16_bf16 v[112:127], a[28:31], v[140:143], v[112:127]
    v_fma_f32 v76, v76, v14, v16
    v_fma_f32 v77, v77, v14, v16
    v_fma_f32 v78, v78, v14, v16
    v_fma_f32 v79, v79, v14, v16
    v_mfma_f32_32x32x16_bf16 v[112:127], a[36:39], v[36:39], v[112:127]
    ds_write_b128 v235, v[96:99] offset:4096
    v_mfma_f32_32x32x16_bf16 v[112:127], a[44:47], v[44:47], v[112:127]
    ds_write_b128 v235, v[100:103] offset:5120
    v_mfma_f32_32x32x16_bf16 v[112:127], a[52:55], v[52:55], v[112:127]
    ds_write_b128 v235, v[104:107] offset:6144
    v_mfma_f32_32x32x16_bf16 v[112:127], a[60:63], v[60:63], v[112:127]
    ds_write_b128 v235, v[108:111] offset:7168
    v_mfma_f32_32x32x16_bf16 v[64:79], a[0:3], v[192:195], v[64:79]
    v_mfma_f32_32x32x16_bf16 v[64:79], a[8:11], v[200:203], v[64:79]
    s_nop 8
    ds_write_b128 v239, v[112:115] offset:32768
    v_mfma_f32_32x32x16_bf16 v[64:79], a[16:19], v[128:131], v[64:79]
    ds_write_b128 v239, v[116:119] offset:33792
    v_mfma_f32_32x32x16_bf16 v[64:79], a[24:27], v[136:139], v[64:79]
    ds_write_b128 v239, v[120:123] offset:34816
    v_mfma_f32_32x32x16_bf16 v[64:79], a[32:35], v[32:35], v[64:79]
    ds_write_b128 v239, v[124:127] offset:35840
    v_mfma_f32_32x32x16_bf16 v[64:79], a[40:43], v[40:43], v[64:79]
    v_mfma_f32_32x32x16_bf16 v[64:79], a[48:51], v[48:51], v[64:79]
    v_mfma_f32_32x32x16_bf16 v[64:79], a[56:59], v[56:59], v[64:79]
    s_waitcnt lgkmcnt(0)
    s_barrier
    ds_read_b128 v[80:83], v233 offset:0
    ds_read_b128 v[84:87], v233 offset:1024
    ds_read_b128 v[88:91], v233 offset:2048
    ds_read_b128 v[92:95], v233 offset:3072
    ds_read_b128 v[96:99], v233 offset:4096
    ds_read_b128 v[100:103], v233 offset:5120
    ds_read_b128 v[104:107], v233 offset:6144
    ds_read_b128 v[108:111], v233 offset:7168
    ds_read_b128 v[112:115], v233 offset:32768
    ds_read_b128 v[116:119], v233 offset:33792
    ds_read_b128 v[120:123], v233 offset:34816
    ds_read_b128 v[124:127], v233 offset:35840
    s_waitcnt lgkmcnt(8)
    v_pk_add_f32 v[64:65], v[64:65], v[80:81]
    v_pk_add_f32 v[66:67], v[66:67], v[82:83]
    v_pk_add_f32 v[68:69], v[68:69], v[84:85]
    v_pk_add_f32 v[70:71], v[70:71], v[86:87]
    v_pk_add_f32 v[72:73], v[72:73], v[88:89]
    v_pk_add_f32 v[74:75], v[74:75], v[90:91]
    v_pk_add_f32 v[76:77], v[76:77], v[92:93]
    v_pk_add_f32 v[78:79], v[78:79], v[94:95]
    s_waitcnt lgkmcnt(4)
    v_pk_add_f32 v[64:65], v[64:65], v[96:97]
    v_pk_add_f32 v[66:67], v[66:67], v[98:99]
    v_pk_add_f32 v[68:69], v[68:69], v[100:101]
    v_pk_add_f32 v[70:71], v[70:71], v[102:103]
    v_pk_add_f32 v[72:73], v[72:73], v[104:105]
    v_pk_add_f32 v[74:75], v[74:75], v[106:107]
    v_pk_add_f32 v[76:77], v[76:77], v[108:109]
    v_pk_add_f32 v[78:79], v[78:79], v[110:111]
    s_waitcnt lgkmcnt(0)
    v_pk_add_f32 v[64:65], v[64:65], v[112:113]
    v_pk_add_f32 v[66:67], v[66:67], v[114:115]
    v_pk_add_f32 v[68:69], v[68:69], v[116:117]
    v_pk_add_f32 v[70:71], v[70:71], v[118:119]
    v_pk_add_f32 v[72:73], v[72:73], v[120:121]
    v_pk_add_f32 v[74:75], v[74:75], v[122:123]
    v_pk_add_f32 v[76:77], v[76:77], v[124:125]
    v_pk_add_f32 v[78:79], v[78:79], v[126:127]
    v_cvt_pk_bf16_f32 v32, v64, v65
    v_cvt_pk_bf16_f32 v33, v66, v67
    v_cvt_pk_bf16_f32 v34, v68, v69
    v_cvt_pk_bf16_f32 v35, v70, v71
    v_cvt_pk_bf16_f32 v36, v72, v73
    v_cvt_pk_bf16_f32 v37, v74, v75
    v_cvt_pk_bf16_f32 v38, v76, v77
    v_cvt_pk_bf16_f32 v39, v78, v79
    v_permlane32_swap_b32 v32, v34
    v_permlane32_swap_b32 v33, v35
    buffer_store_dwordx4 v[32:35], v17, s[20:23], s76 offen offset:0
    v_permlane32_swap_b32 v36, v38
    v_permlane32_swap_b32 v37, v39
    buffer_store_dwordx4 v[36:39], v17, s[20:23], s76 offen offset:32
L_end:
    s_endpgm
.p2align 8
L_table:
.long 0x65832140, 0xfedba9c7, 0x5321c840, 0xdba976, 0x76532410, 0x3210, 0x0, 0x0
.long 0x21c76504, 0xba9fed83, 0x17658a04, 0x9dcb32, 0x32176054, 0x3210, 0x0, 0x0
.long 0x65832140, 0xfedba9c7, 0x5321c840, 0xdba976, 0x32176054, 0x3210, 0x0, 0x0
.long 0x21c76504, 0xba9fed83, 0x17658a04, 0x9dcb32, 0x76532410, 0x3210, 0x0, 0x0
.long 0x65832140, 0xfedba9c7, 0x5321c840, 0xdba976, 0x76532410, 0x3210, 0x0, 0x0
.long 0x21c76504, 0xba9fed83, 0x17658a04, 0x9dcb32, 0x32176054, 0x3210, 0x0, 0x0
.long 0x65832140, 0xfedba9c7, 0x5321c840, 0xdba976, 0x32176054, 0x3210, 0x0, 0x0
.long 0x21c76504, 0xba9fed83, 0x17658a04, 0x9dcb32, 0x76532410, 0x3210, 0x0, 0x0
.long 0x79603521, 0xcfe8bda4, 0x60d93251, 0xc8ba47, 0x47603521, 0x321, 0x0, 0x0
.long 0x3d247165, 0x8bacf9e0, 0x249b7615, 0x8adc03, 0x3247165, 0x321, 0x0, 0x0
.long 0x79603521, 0xcfe8bda4, 0x60d93251, 0xc8ba47, 0x3247165, 0x321, 0x0, 0x0
.long 0x3d247165, 0x8bacf9e0, 0x249b7615, 0x8adc03, 0x47603521, 0x321, 0x0, 0x0
.long 0x79603521, 0xcfe8bda4, 0x60d93251, 0xc8ba47, 0x47603521, 0x321, 0x0, 0x0
.long 0x3d247165, 0x8bacf9e0, 0x249b7615, 0x8adc03, 0x3247165, 0x321, 0x0, 0x0
.long 0x79603521, 0xcfe8bda4, 0x60d93251, 0xc8ba47, 0x3247165, 0x321, 0x0, 0x0
.long 0x3d247165, 0x8bacf9e0, 0x249b7615, 0x8adc03, 0x47603521, 0x321, 0x0, 0x0
.long 0xa4716032, 0xdcf9e8b5, 0xca710362, 0xd98b54, 0x54716032, 0x1032, 0x0, 0x0
.long 0xe0352476, 0x98bdacf1, 0x8c354726, 0x9bad10, 0x10352476, 0x1032, 0x0, 0x0
.long 0xa4716032, 0xdcf9e8b5, 0xca710362, 0xd98b54, 0x10352476, 0x1032, 0x0, 0x0
.long 0xe0352476, 0x98bdacf1, 0x8c354726, 0x9bad10, 0x54716032, 0x1032, 0x0, 0x0
.long 0xa4716032, 0xdcf9e8b5, 0xca710362, 0xd98b54, 0x54716032, 0x1032, 0x0, 0x0
.long 0xe0352476, 0x98bdacf1, 0x8c354726, 0x9bad10, 0x10352476, 0x1032, 0x0, 0x0
.long 0xa4716032, 0xdcf9e8b5, 0xca710362, 0xd98b54, 0x10352476, 0x1032, 0x0, 0x0
.long 0xe0352476, 0x98bdacf1, 0x8c354726, 0x9bad10, 0x54716032, 0x1032, 0x0, 0x0
.long 0x65472103, 0xedcfa98b, 0x65421073, 0xca98db, 0x65472103, 0x2103, 0x0, 0x0
.long 0x21036547, 0xa98bedcf, 0x21065437, 0x8cba9d, 0x21036547, 0x2103, 0x0, 0x0
.long 0x65472103, 0xedcfa98b, 0x65421073, 0xca98db, 0x21036547, 0x2103, 0x0, 0x0
.long 0x21036547, 0xa98bedcf, 0x21065437, 0x8cba9d, 0x65472103, 0x2103, 0x0, 0x0
.long 0x65472103, 0xedcfa98b, 0x65421073, 0xca98db, 0x65472103, 0x2103, 0x0, 0x0
.long 0x21036547, 0xa98bedcf, 0x21065437, 0x8cba9d, 0x21036547, 0x2103, 0x0, 0x0
.long 0x65472103, 0xedcfa98b, 0x65421073, 0xca98db, 0x21036547, 0x2103, 0x0, 0x0
.long 0x21036547, 0xa98bedcf, 0x21065437, 0x8cba9d, 0x65472103, 0x2103, 0x0, 0x0
.long 0x76903251, 0xcfe8bad4, 0x6032d951, 0xc8ba47, 0x76532410, 0x321, 0x0, 0x0
.long 0x32d47615, 0x8bacfe90, 0x24769b15, 0x8adc03, 0x32176054, 0x321, 0x0, 0x0
.long 0x76903251, 0xcfe8bad4, 0x6032d951, 0xc8ba47, 0x32176054, 0x321, 0x0, 0x0
.long 0x32d47615, 0x8bacfe90, 0x24769b15, 0x8adc03, 0x76532410, 0x321, 0x0, 0x0
.long 0x76903251, 0xcfe8bad4, 0x6032d951, 0xc8ba47, 0x76532410, 0x321, 0x0, 0x0
.long 0x32d47615, 0x8bacfe90, 0x24769b15, 0x8adc03, 0x32176054, 0x321, 0x0, 0x0
.long 0x76903251, 0xcfe8bad4, 0x6032d951, 0xc8ba47, 0x32176054, 0x321, 0x0, 0x0
.long 0x32d47615, 0x8bacfe90, 0x24769b15, 0x8adc03, 0x76532410, 0x321, 0x0, 0x0
.long 0x4a710632, 0xdcf98eb5, 0x71ca0362, 0xd98b54, 0x47603521, 0x1032, 0x0, 0x0
.long 0xe354276, 0x98bdcaf1, 0x358c4726, 0x9bad10, 0x3247165, 0x1032, 0x0, 0x0
.long 0x4a710632, 0xdcf98eb5, 0x71ca0362, 0xd98b54, 0x3247165, 0x1032, 0x0, 0x0
.long 0xe354276, 0x98bdcaf1, 0x358c4726, 0x9bad10, 0x47603521, 0x1032, 0x0, 0x0
.long 0x4a710632, 0xdcf98eb5, 0x71ca0362, 0xd98b54, 0x47603521, 0x1032, 0x0, 0x0
.long 0xe354276, 0x98bdcaf1, 0x358c4726, 0x9bad10, 0x3247165, 0x1032, 0x0, 0x0
.long 0x4a710632, 0xdcf98eb5, 0x71ca0362, 0xd98b54, 0x3247165, 0x1032, 0x0, 0x0
.long 0xe354276, 0x98bdcaf1, 0x358c4726, 0x9bad10, 0x47603521, 0x1032, 0x0, 0x0
.long 0xb5427103, 0xedcaf986, 0xdb421073, 0xca9865, 0x54716032, 0x2103, 0x0, 0x0
.long 0xf1063547, 0xa98ebdc2, 0x9d065437, 0x8cba21, 0x10352476, 0x2103, 0x0, 0x0
.long 0xb5427103, 0xedcaf986, 0xdb421073, 0xca9865, 0x10352476, 0x2103, 0x0, 0x0
.long 0xf1063547, 0xa98ebdc2, 0x9d065437, 0x8cba21, 0x54716032, 0x2103, 0x0, 0x0
.long 0xb5427103, 0xedcaf986, 0xdb421073, 0xca9865, 0x54716032, 0x2103, 0x0, 0x0
.long 0xf1063547, 0xa98ebdc2, 0x9d065437, 0x8cba21, 0x10352476, 0x2103, 0x0, 0x0
.long 0xb5427103, 0xedcaf986, 0xdb421073, 0xca9865, 0x10352476, 0x2103, 0x0, 0x0
.long 0xf1063547, 0xa98ebdc2, 0x9d065437, 0x8cba21, 0x54716032, 0x2103, 0x0, 0x0
.long 0x76543210, 0xfedcba98, 0x76532140, 0xdba9c8, 0x65472103, 0x3210, 0x0, 0x0
.long 0x32107654, 0xba98fedc, 0x32176504, 0x9dcb8a, 0x21036547, 0x3210, 0x0, 0x0
.long 0x76543210, 0xfedcba98, 0x76532140, 0xdba9c8, 0x21036547, 0x3210, 0x0, 0x0
.long 0x32107654, 0xba98fedc, 0x32176504, 0x9dcb8a, 0x65472103, 0x3210, 0x0, 0x0
.long 0x76543210, 0xfedcba98, 0x76532140, 0xdba9c8, 0x65472103, 0x3210, 0x0, 0x0
.long 0x32107654, 0xba98fedc, 0x32176504, 0x9dcb8a, 0x21036547, 0x3210, 0x0, 0x0
.long 0x76543210, 0xfedcba98, 0x76532140, 0xdba9c8, 0x21036547, 0x3210, 0x0, 0x0
.long 0x32107654, 0xba98fedc, 0x32176504, 0x9dcb8a, 0x65472103, 0x3210, 0x0, 0x0
.long 0x47a10362, 0xdcf98be5, 0x7103ca62, 0xd98b54, 0x47603521, 0x1032, 0x0, 0x0
.long 0x3e54726, 0x98bdcfa1, 0x35478c26, 0x9bad10, 0x3247165, 0x1032, 0x0, 0x0
.long 0x47a10362, 0xdcf98be5, 0x7103ca62, 0xd98b54, 0x3247165, 0x1032, 0x0, 0x0
.long 0x3e54726, 0x98bdcfa1, 0x35478c26, 0x9bad10, 0x47603521, 0x1032, 0x0, 0x0
.long 0x47a10362, 0xdcf98be5, 0x7103ca62, 0xd98b54, 0x47603521, 0x1032, 0x0, 0x0
.long 0x3e54726, 0x98bdcfa1, 0x35478c26, 0x9bad10, 0x3247165, 0x1032, 0x0, 0x0
.long 0x47a10362, 0xdcf98be5, 0x7103ca62, 0xd98b54, 0x3247165, 0x1032, 0x0, 0x0
.long 0x3e54726, 0x98bdcfa1, 0x35478c26, 0x9bad10, 0x47603521, 0x1032, 0x0, 0x0
.long 0x5b421703, 0xedca9f86, 0x42db1073, 0xca9865, 0x54710632, 0x2103, 0x0, 0x0
.long 0x1f065347, 0xa98edbc2, 0x69d5437, 0x8cba21, 0x10354276, 0x2103, 0x0, 0x0
.long 0x5b421703, 0xedca9f86, 0x42db1073, 0xca9865, 0x10354276, 0x2103, 0x0, 0x0
.long 0x1f065347, 0xa98edbc2, 0x69d5437, 0x8cba21, 0x54710632, 0x2103, 0x0, 0x0
.long 0x5b421703, 0xedca9f86, 0x42db1073, 0xca9865, 0x54710632, 0x2103, 0x0, 0x0
.long 0x1f065347, 0xa98edbc2, 0x69d5437, 0x8cba21, 0x10354276, 0x2103, 0x0, 0x0
.long 0x5b421703, 0xedca9f86, 0x42db1073, 0xca9865, 0x10354276, 0x2103, 0x0, 0x0
.long 0x1f065347, 0xa98edbc2, 0x69d5437, 0x8cba21, 0x54710632, 0x2103, 0x0, 0x0
.long 0x86534210, 0xfedbca97, 0xc8532140, 0xdba976, 0x65427103, 0x3210, 0x0, 0x0
.long 0xc2170654, 0xba9f8ed3, 0x8a176504, 0x9dcb32, 0x21063547, 0x3210, 0x0, 0x0
.long 0x86534210, 0xfedbca97, 0xc8532140, 0xdba976, 0x21063547, 0x3210, 0x0, 0x0
.long 0xc2170654, 0xba9f8ed3, 0x8a176504, 0x9dcb32, 0x65427103, 0x3210, 0x0, 0x0
.long 0x86534210, 0xfedbca97, 0xc8532140, 0xdba976, 0x65427103, 0x3210, 0x0, 0x0
.long 0xc2170654, 0xba9f8ed3, 0x8a176504, 0x9dcb32, 0x21063547, 0x3210, 0x0, 0x0
.long 0x86534210, 0xfedbca97, 0xc8532140, 0xdba976, 0x21063547, 0x3210, 0x0, 0x0
.long 0xc2170654, 0xba9f8ed3, 0x8a176504, 0x9dcb32, 0x65427103, 0x3210, 0x0, 0x0
.long 0x47650321, 0xcfed8ba9, 0x47603251, 0xc8bad9, 0x76543210, 0x321, 0x0, 0x0
.long 0x3214765, 0x8ba9cfed, 0x3247615, 0x8adc9b, 0x32107654, 0x321, 0x0, 0x0
.long 0x47650321, 0xcfed8ba9, 0x47603251, 0xc8bad9, 0x32107654, 0x321, 0x0, 0x0
.long 0x3214765, 0x8ba9cfed, 0x3247615, 0x8adc9b, 0x76543210, 0x321, 0x0, 0x0
.long 0x47650321, 0xcfed8ba9, 0x47603251, 0xc8bad9, 0x76543210, 0x321, 0x0, 0x0
.long 0x3214765, 0x8ba9cfed, 0x3247615, 0x8adc9b, 0x32107654, 0x321, 0x0, 0x0
.long 0x47650321, 0xcfed8ba9, 0x47603251, 0xc8bad9, 0x32107654, 0x321, 0x0, 0x0
.long 0x3214765, 0x8ba9cfed, 0x3247615, 0x8adc9b, 0x76543210, 0x321, 0x0, 0x0
.long 0x54b21073, 0xedca98f6, 0x4210db73, 0xca9865, 0x47603521, 0x2103, 0x0, 0x0
.long 0x10f65437, 0xa98edcb2, 0x6549d37, 0x8cba21, 0x3247165, 0x2103, 0x0, 0x0
.long 0x54b21073, 0xedca98f6, 0x4210db73, 0xca9865, 0x3247165, 0x2103, 0x0, 0x0
.long 0x10f65437, 0xa98edcb2, 0x6549d37, 0x8cba21, 0x47603521, 0x2103, 0x0, 0x0
.long 0x54b21073, 0xedca98f6, 0x4210db73, 0xca9865, 0x47603521, 0x2103, 0x0, 0x0
.long 0x10f65437, 0xa98edcb2, 0x6549d37, 0x8cba21, 0x3247165, 0x2103, 0x0, 0x0
.long 0x54b21073, 0xedca98f6, 0x4210db73, 0xca9865, 0x3247165, 0x2103, 0x0, 0x0
.long 0x10f65437, 0xa98edcb2, 0x6549d37, 0x8cba21, 0x47603521, 0x2103, 0x0, 0x0
.long 0x68532410, 0xfedbac97, 0x53c82140, 0xdba976, 0x54710632, 0x3210, 0x0, 0x0
.long 0x2c176054, 0xba9fe8d3, 0x178a6504, 0x9dcb32, 0x10354276, 0x3210, 0x0, 0x0
.long 0x68532410, 0xfedbac97, 0x53c82140, 0xdba976, 0x10354276, 0x3210, 0x0, 0x0
.long 0x2c176054, 0xba9fe8d3, 0x178a6504, 0x9dcb32, 0x54710632, 0x3210, 0x0, 0x0
.long 0x68532410, 0xfedbac97, 0x53c82140, 0xdba976, 0x54710632, 0x3210, 0x0, 0x0
.long 0x2c176054, 0xba9fe8d3, 0x178a6504, 0x9dcb32, 0x10354276, 0x3210, 0x0, 0x0
.long 0x68532410, 0xfedbac97, 0x53c82140, 0xdba976, 0x10354276, 0x3210, 0x0, 0x0
.long 0x2c176054, 0xba9fe8d3, 0x178a6504, 0x9dcb32, 0x54710632, 0x3210, 0x0, 0x0
.long 0x97605321, 0xcfe8dba4, 0xd9603251, 0xc8ba47, 0x65427103, 0x321, 0x0, 0x0
.long 0xd3241765, 0x8bac9fe0, 0x9b247615, 0x8adc03, 0x21063547, 0x321, 0x0, 0x0
.long 0x97605321, 0xcfe8dba4, 0xd9603251, 0xc8ba47, 0x21063547, 0x321, 0x0, 0x0
.long 0xd3241765, 0x8bac9fe0, 0x9b247615, 0x8adc03, 0x65427103, 0x321, 0x0, 0x0
.long 0x97605321, 0xcfe8dba4, 0xd9603251, 0xc8ba47, 0x65427103, 0x321, 0x0, 0x0
.long 0xd3241765, 0x8bac9fe0, 0x9b247615, 0x8adc03, 0x21063547, 0x321, 0x0, 0x0
.long 0x97605321, 0xcfe8dba4, 0xd9603251, 0xc8ba47, 0x21063547, 0x321, 0x0, 0x0
.long 0xd3241765, 0x8bac9fe0, 0x9b247615, 0x8adc03, 0x65427103, 0x321, 0x0, 0x0
.long 0x54761032, 0xdcfe98ba, 0x54710362, 0xd98bca, 0x76543210, 0x1032, 0x0, 0x0
.long 0x10325476, 0x98badcfe, 0x10354726, 0x9bad8c, 0x32107654, 0x1032, 0x0, 0x0
.long 0x54761032, 0xdcfe98ba, 0x54710362, 0xd98bca, 0x32107654, 0x1032, 0x0, 0x0
.long 0x10325476, 0x98badcfe, 0x10354726, 0x9bad8c, 0x76543210, 0x1032, 0x0, 0x0
.long 0x54761032, 0xdcfe98ba, 0x54710362, 0xd98bca, 0x76543210, 0x1032, 0x0, 0x0
.long 0x10325476, 0x98badcfe, 0x10354726, 0x9bad8c, 0x32107654, 0x1032, 0x0, 0x0
.long 0x54761032, 0xdcfe98ba, 0x54710362, 0xd98bca, 0x32107654, 0x1032, 0x0, 0x0
.long 0x10325476, 0x98badcfe, 0x10354726, 0x9bad8c, 0x76543210, 0x1032, 0x0, 0x0
.long 0x65832140, 0xfedba9c7, 0x5321c840, 0xdba976, 0x54710632, 0x3210, 0x0, 0x0
.long 0x21c76504, 0xba9fed83, 0x17658a04, 0x9dcb32, 0x10354276, 0x3210, 0x0, 0x0
.long 0x65832140, 0xfedba9c7, 0x5321c840, 0xdba976, 0x10354276, 0x3210, 0x0, 0x0
.long 0x21c76504, 0xba9fed83, 0x17658a04, 0x9dcb32, 0x54710632, 0x3210, 0x0, 0x0
.long 0x65832140, 0xfedba9c7, 0x5321c840, 0xdba976, 0x54710632, 0x3210, 0x0, 0x0
.long 0x21c76504, 0xba9fed83, 0x17658a04, 0x9dcb32, 0x10354276, 0x3210, 0x0, 0x0
.long 0x65832140, 0xfedba9c7, 0x5321c840, 0xdba976, 0x10354276, 0x3210, 0x0, 0x0
.long 0x21c76504, 0xba9fed83, 0x17658a04, 0x9dcb32, 0x54710632, 0x3210, 0x0, 0x0
.long 0x79603521, 0xcfe8bda4, 0x60d93251, 0xc8ba47, 0x65421703, 0x321, 0x0, 0x0
.long 0x3d247165, 0x8bacf9e0, 0x249b7615, 0x8adc03, 0x21065347, 0x321, 0x0, 0x0
.long 0x79603521, 0xcfe8bda4, 0x60d93251, 0xc8ba47, 0x21065347, 0x321, 0x0, 0x0
.long 0x3d247165, 0x8bacf9e0, 0x249b7615, 0x8adc03, 0x65421703, 0x321, 0x0, 0x0
.long 0x79603521, 0xcfe8bda4, 0x60d93251, 0xc8ba47, 0x65421703, 0x321, 0x0, 0x0
.long 0x3d247165, 0x8bacf9e0, 0x249b7615, 0x8adc03, 0x21065347, 0x321, 0x0, 0x0
.long 0x79603521, 0xcfe8bda4, 0x60d93251, 0xc8ba47, 0x21065347, 0x321, 0x0, 0x0
.long 0x3d247165, 0x8bacf9e0, 0x249b7615, 0x8adc03, 0x65421703, 0x321, 0x0, 0x0
.long 0xa4716032, 0xdcf9e8b5, 0xca710362, 0xd98b54, 0x76534210, 0x1032, 0x0, 0x0
.long 0xe0352476, 0x98bdacf1, 0x8c354726, 0x9bad10, 0x32170654, 0x1032, 0x0, 0x0
.long 0xa4716032, 0xdcf9e8b5, 0xca710362, 0xd98b54, 0x32170654, 0x1032, 0x0, 0x0
.long 0xe0352476, 0x98bdacf1, 0x8c354726, 0x9bad10, 0x76534210, 0x1032, 0x0, 0x0
.long 0xa4716032, 0xdcf9e8b5, 0xca710362, 0xd98b54, 0x76534210, 0x1032, 0x0, 0x0
.long 0xe0352476, 0x98bdacf1, 0x8c354726, 0x9bad10, 0x32170654, 0x1032, 0x0, 0x0
.long 0xa4716032, 0xdcf9e8b5, 0xca710362, 0xd98b54, 0x32170654, 0x1032, 0x0, 0x0
.long 0xe0352476, 0x98bdacf1, 0x8c354726, 0x9bad10, 0x76534210, 0x1032, 0x0, 0x0
.long 0x65472103, 0xedcfa98b, 0x65421073, 0xca98db, 0x47650321, 0x2103, 0x0, 0x0
.long 0x21036547, 0xa98bedcf, 0x21065437, 0x8cba9d, 0x3214765, 0x2103, 0x0, 0x0
.long 0x65472103, 0xedcfa98b, 0x65421073, 0xca98db, 0x3214765, 0x2103, 0x0, 0x0
.long 0x21036547, 0xa98bedcf, 0x21065437, 0x8cba9d, 0x47650321, 0x2103, 0x0, 0x0
.long 0x65472103, 0xedcfa98b, 0x65421073, 0xca98db, 0x47650321, 0x2103, 0x0, 0x0
.long 0x21036547, 0xa98bedcf, 0x21065437, 0x8cba9d, 0x3214765, 0x2103, 0x0, 0x0
.long 0x65472103, 0xedcfa98b, 0x65421073, 0xca98db, 0x3214765, 0x2103, 0x0, 0x0
.long 0x21036547, 0xa98bedcf, 0x21065437, 0x8cba9d, 0x47650321, 0x2103, 0x0, 0x0
.long 0x76903251, 0xcfe8bad4, 0x6032d951, 0xc8ba47, 0x54710632, 0x321, 0x0, 0x0
.long 0x32d47615, 0x8bacfe90, 0x24769b15, 0x8adc03, 0x10354276, 0x321, 0x0, 0x0
.long 0x76903251, 0xcfe8bad4, 0x6032d951, 0xc8ba47, 0x10354276, 0x321, 0x0, 0x0
.long 0x32d47615, 0x8bacfe90, 0x24769b15, 0x8adc03, 0x54710632, 0x321, 0x0, 0x0
.long 0x76903251, 0xcfe8bad4, 0x6032d951, 0xc8ba47, 0x54710632, 0x321, 0x0, 0x0
.long 0x32d47615, 0x8bacfe90, 0x24769b15, 0x8adc03, 0x10354276, 0x321, 0x0, 0x0
.long 0x76903251, 0xcfe8bad4, 0x6032d951, 0xc8ba47, 0x10354276, 0x321, 0x0, 0x0
.long 0x32d47615, 0x8bacfe90, 0x24769b15, 0x8adc03, 0x54710632, 0x321, 0x0, 0x0
.long 0x4a710632, 0xdcf98eb5, 0x71ca0362, 0xd98b54, 0x65421703, 0x1032, 0x0, 0x0
.long 0xe354276, 0x98bdcaf1, 0x358c4726, 0x9bad10, 0x21065347, 0x1032, 0x0, 0x0
.long 0x4a710632, 0xdcf98eb5, 0x71ca0362, 0xd98b54, 0x21065347, 0x1032, 0x0, 0x0
.long 0xe354276, 0x98bdcaf1, 0x358c4726, 0x9bad10, 0x65421703, 0x1032, 0x0, 0x0
.long 0x4a710632, 0xdcf98eb5, 0x71ca0362, 0xd98b54, 0x65421703, 0x1032, 0x0, 0x0
.long 0xe354276, 0x98bdcaf1, 0x358c4726, 0x9bad10, 0x21065347, 0x1032, 0x0, 0x0
.long 0x4a710632, 0xdcf98eb5, 0x71ca0362, 0xd98b54, 0x21065347, 0x1032, 0x0, 0x0
.long 0xe354276, 0x98bdcaf1, 0x358c4726, 0x9bad10, 0x65421703, 0x1032, 0x0, 0x0
.long 0xb5427103, 0xedcaf986, 0xdb421073, 0xca9865, 0x76534210, 0x2103, 0x0, 0x0
.long 0xf1063547, 0xa98ebdc2, 0x9d065437, 0x8cba21, 0x32170654, 0x2103, 0x0, 0x0
.long 0xb5427103, 0xedcaf986, 0xdb421073, 0xca9865, 0x32170654, 0x2103, 0x0, 0x0
.long 0xf1063547, 0xa98ebdc2, 0x9d065437, 0x8cba21, 0x76534210, 0x2103, 0x0, 0x0
.long 0xb5427103, 0xedcaf986, 0xdb421073, 0xca9865, 0x76534210, 0x2103, 0x0, 0x0
.long 0xf1063547, 0xa98ebdc2, 0x9d065437, 0x8cba21, 0x32170654, 0x2103, 0x0, 0x0
.long 0xb5427103, 0xedcaf986, 0xdb421073, 0xca9865, 0x32170654, 0x2103, 0x0, 0x0
.long 0xf1063547, 0xa98ebdc2, 0x9d065437, 0x8cba21, 0x76534210, 0x2103, 0x0, 0x0
.long 0x76543210, 0xfedcba98, 0x76532140, 0xdba9c8, 0x47650321, 0x3210, 0x0, 0x0
.long 0x32107654, 0xba98fedc, 0x32176504, 0x9dcb8a, 0x3214765, 0x3210, 0x0, 0x0
.long 0x76543210, 0xfedcba98, 0x76532140, 0xdba9c8, 0x3214765, 0x3210, 0x0, 0x0
.long 0x32107654, 0xba98fedc, 0x32176504, 0x9dcb8a, 0x47650321, 0x3210, 0x0, 0x0
.long 0x76543210, 0xfedcba98, 0x76532140, 0xdba9c8, 0x47650321, 0x3210, 0x0, 0x0
.long 0x32107654, 0xba98fedc, 0x32176504, 0x9dcb8a, 0x3214765, 0x3210, 0x0, 0x0
.long 0x76543210, 0xfedcba98, 0x76532140, 0xdba9c8, 0x3214765, 0x3210, 0x0, 0x0
.long 0x32107654, 0xba98fedc, 0x32176504, 0x9dcb8a, 0x47650321, 0x3210, 0x0, 0x0
.long 0x47a10362, 0xdcf98be5, 0x7103ca62, 0xd98b54, 0x65421703, 0x1032, 0x0, 0x0
.long 0x3e54726, 0x98bdcfa1, 0x35478c26, 0x9bad10, 0x21065347, 0x1032, 0x0, 0x0
.long 0x47a10362, 0xdcf98be5, 0x7103ca62, 0xd98b54, 0x21065347, 0x1032, 0x0, 0x0
.long 0x3e54726, 0x98bdcfa1, 0x35478c26, 0x9bad10, 0x65421703, 0x1032, 0x0, 0x0
.long 0x47a10362, 0xdcf98be5, 0x7103ca62, 0xd98b54, 0x65421703, 0x1032, 0x0, 0x0
.long 0x3e54726, 0x98bdcfa1, 0x35478c26, 0x9bad10, 0x21065347, 0x1032, 0x0, 0x0
.long 0x47a10362, 0xdcf98be5, 0x7103ca62, 0xd98b54, 0x21065347, 0x1032, 0x0, 0x0
.long 0x3e54726, 0x98bdcfa1, 0x35478c26, 0x9bad10, 0x65421703, 0x1032, 0x0, 0x0
.long 0x5b421703, 0xedca9f86, 0x42db1073, 0xca9865, 0x76532410, 0x2103, 0x0, 0x0
.long 0x1f065347, 0xa98edbc2, 0x69d5437, 0x8cba21, 0x32176054, 0x2103, 0x0, 0x0
.long 0x5b421703, 0xedca9f86, 0x42db1073, 0xca9865, 0x32176054, 0x2103, 0x0, 0x0
.long 0x1f065347, 0xa98edbc2, 0x69d5437, 0x8cba21, 0x76532410, 0x2103, 0x0, 0x0
.long 0x5b421703, 0xedca9f86, 0x42db1073, 0xca9865, 0x76532410, 0x2103, 0x0, 0x0
.long 0x1f065347, 0xa98edbc2, 0x69d5437, 0x8cba21, 0x32176054, 0x2103, 0x0, 0x0
.long 0x5b421703, 0xedca9f86, 0x42db1073, 0xca9865, 0x32176054, 0x2103, 0x0, 0x0
.long 0x1f065347, 0xa98edbc2, 0x69d5437, 0x8cba21, 0x76532410, 0x2103, 0x0, 0x0
.long 0x86534210, 0xfedbca97, 0xc8532140, 0xdba976, 0x47605321, 0x3210, 0x0, 0x0
.long 0xc2170654, 0xba9f8ed3, 0x8a176504, 0x9dcb32, 0x3241765, 0x3210, 0x0, 0x0
.long 0x86534210, 0xfedbca97, 0xc8532140, 0xdba976, 0x3241765, 0x3210, 0x0, 0x0
.long 0xc2170654, 0xba9f8ed3, 0x8a176504, 0x9dcb32, 0x47605321, 0x3210, 0x0, 0x0
.long 0x86534210, 0xfedbca97, 0xc8532140, 0xdba976, 0x47605321, 0x3210, 0x0, 0x0
.long 0xc2170654, 0xba9f8ed3, 0x8a176504, 0x9dcb32, 0x3241765, 0x3210, 0x0, 0x0
.long 0x86534210, 0xfedbca97, 0xc8532140, 0xdba976, 0x3241765, 0x3210, 0x0, 0x0
.long 0xc2170654, 0xba9f8ed3, 0x8a176504, 0x9dcb32, 0x47605321, 0x3210, 0x0, 0x0
.long 0x47650321, 0xcfed8ba9, 0x47603251, 0xc8bad9, 0x54761032, 0x321, 0x0, 0x0
.long 0x3214765, 0x8ba9cfed, 0x3247615, 0x8adc9b, 0x10325476, 0x321, 0x0, 0x0
.long 0x47650321, 0xcfed8ba9, 0x47603251, 0xc8bad9, 0x10325476, 0x321, 0x0, 0x0
.long 0x3214765, 0x8ba9cfed, 0x3247615, 0x8adc9b, 0x54761032, 0x321, 0x0, 0x0
.long 0x47650321, 0xcfed8ba9, 0x47603251, 0xc8bad9, 0x54761032, 0x321, 0x0, 0x0
.long 0x3214765, 0x8ba9cfed, 0x3247615, 0x8adc9b, 0x10325476, 0x321, 0x0, 0x0
.long 0x47650321, 0xcfed8ba9, 0x47603251, 0xc8bad9, 0x10325476, 0x321, 0x0, 0x0
.long 0x3214765, 0x8ba9cfed, 0x3247615, 0x8adc9b, 0x54761032, 0x321, 0x0, 0x0
.long 0x54b21073, 0xedca98f6, 0x4210db73, 0xca9865, 0x65421703, 0x2103, 0x0, 0x0
.long 0x10f65437, 0xa98edcb2, 0x6549d37, 0x8cba21, 0x21065347, 0x2103, 0x0, 0x0
.long 0x54b21073, 0xedca98f6, 0x4210db73, 0xca9865, 0x21065347, 0x2103, 0x0, 0x0
.long 0x10f65437, 0xa98edcb2, 0x6549d37, 0x8cba21, 0x65421703, 0x2103, 0x0, 0x0
.long 0x54b21073, 0xedca98f6, 0x4210db73, 0xca9865, 0x65421703, 0x2103, 0x0, 0x0
.long 0x10f65437, 0xa98edcb2, 0x6549d37, 0x8cba21, 0x21065347, 0x2103, 0x0, 0x0
.long 0x54b21073, 0xedca98f6, 0x4210db73, 0xca9865, 0x21065347, 0x2103, 0x0, 0x0
.long 0x10f65437, 0xa98edcb2, 0x6549d37, 0x8cba21, 0x65421703, 0x2103, 0x0, 0x0
.long 0x68532410, 0xfedbac97, 0x53c82140, 0xdba976, 0x76532410, 0x3210, 0x0, 0x0
.long 0x2c176054, 0xba9fe8d3, 0x178a6504, 0x9dcb32, 0x32176054, 0x3210, 0x0, 0x0
.long 0x68532410, 0xfedbac97, 0x53c82140, 0xdba976, 0x32176054, 0x3210, 0x0, 0x0
.long 0x2c176054, 0xba9fe8d3, 0x178a6504, 0x9dcb32, 0x76532410, 0x3210, 0x0, 0x0
.long 0x68532410, 0xfedbac97, 0x53c82140, 0xdba976, 0x76532410, 0x3210, 0x0, 0x0
.long 0x2c176054, 0xba9fe8d3, 0x178a6504, 0x9dcb32, 0x32176054, 0x3210, 0x0, 0x0
.long 0x68532410, 0xfedbac97, 0x53c82140, 0xdba976, 0x32176054, 0x3210, 0x0, 0x0
.long 0x2c176054, 0xba9fe8d3, 0x178a6504, 0x9dcb32, 0x76532410, 0x3210, 0x0, 0x0
.long 0x97605321, 0xcfe8dba4, 0xd9603251, 0xc8ba47, 0x47605321, 0x321, 0x0, 0x0
.long 0xd3241765, 0x8bac9fe0, 0x9b247615, 0x8adc03, 0x3241765, 0x321, 0x0, 0x0
.long 0x97605321, 0xcfe8dba4, 0xd9603251, 0xc8ba47, 0x3241765, 0x321, 0x0, 0x0
.long 0xd3241765, 0x8bac9fe0, 0x9b247615, 0x8adc03, 0x47605321, 0x321, 0x0, 0x0
.long 0x97605321, 0xcfe8dba4, 0xd9603251, 0xc8ba47, 0x47605321, 0x321, 0x0, 0x0
.long 0xd3241765, 0x8bac9fe0, 0x9b247615, 0x8adc03, 0x3241765, 0x321, 0x0, 0x0
.long 0x97605321, 0xcfe8dba4, 0xd9603251, 0xc8ba47, 0x3241765, 0x321, 0x0, 0x0
.long 0xd3241765, 0x8bac9fe0, 0x9b247615, 0x8adc03, 0x47605321, 0x321, 0x0, 0x0
.long 0x54761032, 0xdcfe98ba, 0x54710362, 0xd98bca, 0x54761032, 0x1032, 0x0, 0x0
.long 0x10325476, 0x98badcfe, 0x10354726, 0x9bad8c, 0x10325476, 0x1032, 0x0, 0x0
.long 0x54761032, 0xdcfe98ba, 0x54710362, 0xd98bca, 0x10325476, 0x1032, 0x0, 0x0
.long 0x10325476, 0x98badcfe, 0x10354726, 0x9bad8c, 0x54761032, 0x1032, 0x0, 0x0
.long 0x54761032, 0xdcfe98ba, 0x54710362, 0xd98bca, 0x54761032, 0x1032, 0x0, 0x0
.long 0x10325476, 0x98badcfe, 0x10354726, 0x9bad8c, 0x10325476, 0x1032, 0x0, 0x0
.long 0x54761032, 0xdcfe98ba, 0x54710362, 0xd98bca, 0x10325476, 0x1032, 0x0, 0x0
.long 0x10325476, 0x98badcfe, 0x10354726, 0x9bad8c, 0x54761032, 0x1032, 0x0, 0x0
.fill 1024, 4, 0xbf800000
.section .rodata,"a"
.p2align 6
.amdhsa_kernel gated_mix__linear_kernel_hedgehog__mixer_token_mlp__prompt_kernel
  .amdhsa_next_free_vgpr 512
  .amdhsa_next_free_sgpr 102
  .amdhsa_accum_offset 256
  .amdhsa_group_segment_fixed_size 0
  .amdhsa_kernarg_size 104
  .amdhsa_user_sgpr_count 2
  .amdhsa_user_sgpr_kernarg_segment_ptr 1
  .amdhsa_system_sgpr_workgroup_id_x 1
.end_amdhsa_kernel
```
